```python
import torch

def _softmax(x, axis=-1):
    return torch.softmax(x, dim=axis)
def _gelu(x):
    return torch.nn.functional.gelu(x, approximate="tanh")
def _silu(x):
    return torch.nn.functional.silu(x)
def _sigmoid(x):
    return torch.sigmoid(x)
def _layernorm(x, axis=-1, eps=1e-5):
    m = x.mean(dim=axis, keepdim=True)
    v = x.var(dim=axis, keepdim=True, unbiased=False)
    return (x - m) / torch.sqrt(v + eps)
def _scatter_add(tgt, idx, src, axis=0):
    return tgt.clone().index_add_(axis, idx, src)
def _segment_sum(src, seg, n):
    out = torch.zeros((n,) + src.shape[1:], dtype=src.dtype)
    return out.index_add_(0, seg, src)
def _pad(x, pw):
    flat = tuple(v for pair in reversed(pw) for v in pair)
    return torch.nn.functional.pad(x, flat)

kernel_name = 'standalone__softmax_full_bidir__prompt'

def setup_inputs():

    _w = (lambda a: (lambda t: t.to(torch.bfloat16) if t.is_floating_point() else t)(torch.as_tensor(a)))
    B, H, Sq, Skv, Dh = 1, 32, 2048, 2048, 128
    return {
        "q": _w((lambda *s: torch.randn(*s, dtype=torch.bfloat16) * 0.8)(B, H, Sq, Dh)),
        "k": _w((lambda *s: torch.randn(*s, dtype=torch.bfloat16) * 0.8)(B, H, Skv, Dh)),
        "v": _w((lambda *s: torch.randn(*s, dtype=torch.bfloat16) * 0.05)(B, H, Skv, Dh)),
    }

def reference(q, k, v):
    scale = q.shape[-1] ** -0.5
    scores = torch.einsum('bhqd,bhkd->bhqk', q, k) * scale
    attn = _softmax(scores, axis=-1)
    return torch.einsum('bhqk,bhkd->bhqd', attn, v)
```

```asm
; @launch grid=(256,1,1) block=(256,1,1) lds=163840
.amdgcn_target "amdgcn-amd-amdhsa--gfx950"
.text
.globl standalone__softmax_full_bidir__prompt_kernel
.p2align 8
.type standalone__softmax_full_bidir__prompt_kernel,@function
standalone__softmax_full_bidir__prompt_kernel:
  s_cmp_ge_u32 s2, 256
  s_cbranch_scc1 L_end
  s_load_dwordx8 s[4:11], s[0:1], 0
  s_getpc_b64 s[80:81]
  L_pc:
  v_lshlrev_b32 v48, 7, v0
  v_lshrrev_b32 v3, 6, v0
  global_load_dword v49, v48, s[80:81]
  v_and_b32 v1, 15, v0
  v_readfirstlane_b32 s28, v3
  v_bfe_u32 v2, v0, 4, 2
  s_and_b32 s40, s2, 7
  s_lshl_b32 s40, s40, 2
  s_lshr_b32 s41, s2, 6
  s_add_u32 s40, s40, s41
  s_lshl_b32 s40, s40, 19
  s_lshr_b32 s41, s2, 3
  s_and_b32 s41, s41, 7
  s_lshl_b32 s41, s41, 16
  s_mul_i32 s42, s28, 12288
  s_add_u32 s41, s41, s42
  s_add_u32 s41, s41, s40
  s_lshl_b32 s31, s28, 12
  s_add_u32 s32, s31, 65536
  s_lshr_b32 s42, s2, 3
  s_add_u32 s42, s42, s28
  s_lshl_b32 s42, s42, 12
  s_add_u32 s3, s42, 0
  s_and_b32 s3, s3, 12288
  s_add_u32 s33, s42, 4096
  s_and_b32 s33, s33, 12288
  s_add_u32 s34, s42, 8192
  s_and_b32 s34, s34, 12288
  s_add_u32 s35, s42, 12288
  s_and_b32 s35, s35, 12288
  s_mov_b32 s18, 524288
  s_mov_b32 s19, 131072
  s_mov_b32 s22, 524288
  s_mov_b32 s23, 131072
  s_add_u32 s14, s31, 16384
  s_mov_b32 s15, 131072
  s_add_u32 s26, s31, 16384
  s_mov_b32 s27, 131072
  v_lshlrev_b32 v3, 8, v2
  v_add_u32 v3, s31, v3
  v_xor_b32 v16, v1, v2
  v_xor_b32 v17, 4, v16
  v_xor_b32 v18, 8, v16
  v_xor_b32 v19, 12, v16
  v_lshl_add_u32 v16, v16, 4, v3
  v_lshl_add_u32 v17, v17, 4, v3
  v_lshl_add_u32 v18, v18, 4, v3
  v_lshl_add_u32 v19, v19, 4, v3
  v_lshlrev_b32 v20, 1, v2
  v_xor_b32 v20, v1, v20
  v_xor_b32 v21, 8, v20
  v_lshl_add_u32 v20, v20, 4, v3
  v_lshl_add_u32 v21, v21, 4, v3
  s_waitcnt lgkmcnt(0)
  s_add_u32 s16, s6, s40
  s_addc_u32 s17, s7, 0
  s_add_u32 s12, s4, s41
  s_addc_u32 s13, s5, 0
  s_add_u32 s20, s8, s40
  s_addc_u32 s21, s9, 0
  s_add_u32 m0, s31, 0
  s_nop 0
  buffer_load_dwordx4 v16, s[16:19], 0 offen sc1 nt lds
  buffer_load_dwordx4 v17, s[16:19], 0 offen offset:1024 sc1 nt lds
  buffer_load_dwordx4 v18, s[16:19], 0 offen offset:2048 sc1 nt lds
  buffer_load_dwordx4 v19, s[16:19], 0 offen offset:3072 sc1 nt lds
  s_add_u32 m0, s31, 98304
  s_nop 0
  buffer_load_dwordx4 v16, s[12:15], s3 offen sc1 nt lds
  buffer_load_dwordx4 v17, s[12:15], s3 offen offset:1024 sc1 nt lds
  buffer_load_dwordx4 v18, s[12:15], s3 offen offset:2048 sc1 nt lds
  buffer_load_dwordx4 v19, s[12:15], s3 offen offset:3072 sc1 nt lds
  s_add_u32 s24, s10, s41
  s_addc_u32 s25, s11, 0
  v_lshlrev_b32 v3, 8, v1
  v_xor_b32 v4, v1, v2
  v_xor_b32 v5, 4, v4
  v_xor_b32 v6, 8, v4
  v_xor_b32 v7, 12, v4
  v_lshl_add_u32 v4, v4, 4, v3
  v_lshl_add_u32 v5, v5, 4, v3
  v_lshl_add_u32 v6, v6, 4, v3
  v_lshl_add_u32 v7, v7, 4, v3
  v_lshrrev_b32 v0, 1, v2
  v_xor_b32 v0, v0, v1
  v_lshl_add_u32 v0, v0, 4, v3
  v_and_b32 v3, 1, v2
  v_lshl_add_u32 v0, v3, 3, v0
  s_lshl_b32 s82, s28, 14
  v_add_u32 v0, s82, v0
  v_lshrrev_b32 v3, 2, v1
  v_lshl_add_u32 v3, v2, 2, v3
  v_and_b32 v8, 7, v3
  v_lshlrev_b32 v3, 8, v3
  v_and_b32 v9, 3, v1
  v_lshl_add_u32 v3, v9, 3, v3
  v_add_u32 v3, 65536, v3
  v_xor_b32 v9, 1, v8
  v_xor_b32 v10, 2, v8
  v_xor_b32 v11, 3, v8
  v_xor_b32 v12, 4, v8
  v_xor_b32 v13, 5, v8
  v_xor_b32 v14, 6, v8
  v_xor_b32 v15, 7, v8
  v_lshl_add_u32 v8, v8, 5, v3
  v_lshl_add_u32 v9, v9, 5, v3
  v_lshl_add_u32 v10, v10, 5, v3
  v_lshl_add_u32 v11, v11, 5, v3
  v_lshl_add_u32 v12, v12, 5, v3
  v_lshl_add_u32 v13, v13, 5, v3
  v_lshl_add_u32 v14, v14, 5, v3
  v_lshl_add_u32 v15, v15, 5, v3
  v_and_b32 v3, 2, v1
  v_cmp_eq_u32 vcc, 0, v3
  v_mov_b32 v3, 0x3f803f80
  v_and_b32 v23, 1, v1
  v_cndmask_b32 v24, 0, v3, vcc
  v_cndmask_b32 v25, 0, v3, vcc
  v_cndmask_b32 v26, 0, v3, vcc
  v_cndmask_b32 v27, 0, v3, vcc
  v_cmp_eq_u32 vcc, 0, v23
  v_mov_b32 v3, 0x44444444
  v_mov_b32 v23, 0xeeeeeeee
  v_cndmask_b32 v23, v23, v3, vcc
  v_mov_b32 v28, 0
  v_mov_b32 v32, 0
  v_mov_b32 v33, 0
  v_mov_b32 v34, 0
  v_mov_b32 v35, 0
  v_mov_b32 v36, 0
  v_mov_b32 v37, 0
  v_mov_b32 v38, 0
  v_mov_b32 v39, 0
  v_mov_b32 v40, 0
  v_mov_b32 v41, 0
  v_mov_b32 v42, 0
  v_mov_b32 v43, 0
  v_mov_b32 v44, 0
  v_mov_b32 v45, 0
  v_mov_b32 v46, 0
  v_mov_b32 v47, 0
  v_accvgpr_write_b32 a24, 0
  v_accvgpr_write_b32 a25, 0
  v_accvgpr_write_b32 a26, 0
  v_accvgpr_write_b32 a27, 0
  v_accvgpr_write_b32 a28, 0
  v_accvgpr_write_b32 a29, 0
  v_accvgpr_write_b32 a30, 0
  v_accvgpr_write_b32 a31, 0
  v_accvgpr_write_b32 a56, 0
  v_accvgpr_write_b32 a57, 0
  v_accvgpr_write_b32 a58, 0
  v_accvgpr_write_b32 a59, 0
  v_accvgpr_write_b32 a60, 0
  v_accvgpr_write_b32 a61, 0
  v_accvgpr_write_b32 a62, 0
  v_accvgpr_write_b32 a63, 0
  v_accvgpr_write_b32 a88, 0
  v_accvgpr_write_b32 a89, 0
  v_accvgpr_write_b32 a90, 0
  v_accvgpr_write_b32 a91, 0
  v_accvgpr_write_b32 a92, 0
  v_accvgpr_write_b32 a93, 0
  v_accvgpr_write_b32 a94, 0
  v_accvgpr_write_b32 a95, 0
  v_accvgpr_write_b32 a120, 0
  v_accvgpr_write_b32 a121, 0
  v_accvgpr_write_b32 a122, 0
  v_accvgpr_write_b32 a123, 0
  v_accvgpr_write_b32 a124, 0
  v_accvgpr_write_b32 a125, 0
  v_accvgpr_write_b32 a126, 0
  v_accvgpr_write_b32 a127, 0
  v_lshrrev_b32 v192, 2, v1
  v_cmp_eq_u32 vcc, v192, v2
  v_and_b32 v193, 1, v1
  v_lshlrev_b32 v193, 4, v193
  v_mov_b32 v194, 0x3e03
  v_mov_b32 v195, 0xb9d8
  v_cndmask_b32 v194, 0, v194, vcc
  v_cndmask_b32 v195, 0, v195, vcc
  v_and_b32 v192, 2, v1
  v_cmp_eq_u32 vcc, 0, v192
  v_lshlrev_b32 v194, v193, v194
  v_lshlrev_b32 v195, v193, v195
  v_cndmask_b32 v196, 0, v194, vcc
  v_cndmask_b32 v197, v194, 0, vcc
  v_accvgpr_write_b32 a114, v196
  v_accvgpr_write_b32 a115, v197
  v_cndmask_b32 v196, 0, v195, vcc
  v_cndmask_b32 v197, v195, 0, vcc
  v_accvgpr_write_b32 a118, v196
  v_accvgpr_write_b32 a119, v197
  v_accvgpr_write_b32 a112, 0
  v_accvgpr_write_b32 a113, 0
  v_accvgpr_write_b32 a116, 0
  v_accvgpr_write_b32 a117, 0
  s_add_u32 s42, s31, 98304
  v_add_u32 v1, s42, v4
  v_add_u32 v2, s42, v5
  v_add_u32 v3, s42, v6
  v_add_u32 v22, s42, v7
  s_mov_b32 s36, 0x3e0293ee
  s_mov_b32 s37, 0x3e0293ee
  s_mov_b32 s83, 0xc0600000
  s_mov_b32 s38, 0x45000000
  s_movk_i32 s30, 7
  s_mov_b32 s29, 98304
  s_mov_b32 s39, 65536
  s_add_u32 m0, s31, 16384
  s_mov_b32 s42, 16384
  buffer_load_dwordx4 v16, s[16:19], s42 offen sc1 nt lds
  buffer_load_dwordx4 v17, s[16:19], s42 offen offset:1024 sc1 nt lds
  buffer_load_dwordx4 v18, s[16:19], s42 offen offset:2048 sc1 nt lds
  buffer_load_dwordx4 v19, s[16:19], s42 offen offset:3072 sc1 nt lds
  s_add_u32 m0, s32, 0
  s_nop 0
  buffer_load_dwordx4 v20, s[20:23], 0 offen sc1 nt lds
  buffer_load_dwordx4 v21, s[20:23], 0 offen offset:1024 sc1 nt lds
  buffer_load_dwordx4 v20, s[20:23], 0 offen offset:2048 sc1 nt lds
  buffer_load_dwordx4 v21, s[20:23], 0 offen offset:3072 sc1 nt lds
  s_waitcnt vmcnt(12)
  s_barrier
  ds_read_b128 v[128:131], v4 offset:0
  ds_read_b128 v[144:147], v4 offset:4096
  ds_read_b128 v[160:163], v4 offset:8192
  ds_read_b128 a[96:99], v4 offset:12288
  ds_read_b128 v[132:135], v5 offset:0
  ds_read_b128 v[148:151], v5 offset:4096
  ds_read_b128 v[164:167], v5 offset:8192
  ds_read_b128 a[100:103], v5 offset:12288
  ds_read_b128 v[136:139], v6 offset:0
  ds_read_b128 v[152:155], v6 offset:4096
  ds_read_b128 v[168:171], v6 offset:8192
  ds_read_b128 a[104:107], v6 offset:12288
  ds_read_b128 v[140:143], v7 offset:0
  ds_read_b128 v[156:159], v7 offset:4096
  ds_read_b128 v[172:175], v7 offset:8192
  ds_read_b128 a[108:111], v7 offset:12288
  s_mov_b64 exec, 0
  s_cmp_eq_u32 s28, 0
  s_cbranch_scc1 L_pad0
  s_cmp_eq_u32 s28, 1
  s_cbranch_scc1 L_pad1
  s_cmp_eq_u32 s28, 2
  s_cbranch_scc1 L_pad2
  s_branch L_pad3
L_back:
  s_mov_b64 exec, -1
  s_branch L_main
  .p2align 12
  L_main:
L_pad0:
  s_cbranch_execz L_pad4
  s_add_u32 m0, s31, 114688
  s_mov_b32 s42, 32768
  s_waitcnt vmcnt(8)
  ds_read_b128 a[128:131], v1 offset:0
  ds_read_b128 a[132:135], v2 offset:0
  buffer_load_dwordx4 v16, s[12:15], s33 offen sc1 nt lds
  buffer_load_dwordx4 v17, s[12:15], s33 offen offset:1024 sc1 nt lds
  ds_read_b128 a[136:139], v3 offset:0
  ds_read_b128 a[140:143], v22 offset:0
  buffer_load_dwordx4 v18, s[12:15], s33 offen offset:2048 sc1 nt lds
  s_waitcnt lgkmcnt(3)
  v_mfma_f32_16x16x32_bf16 v[240:243], a[118:121], a[128:131], 0
  v_mfma_f32_16x16x32_bf16 v[240:243], a[114:117], a[128:131], v[240:243]
  v_mfma_f32_16x16x32_bf16 v[244:247], a[116:119], a[128:131], 0
  buffer_load_dwordx4 v19, s[12:15], s33 offen offset:3072 sc1 nt lds
  v_mfma_f32_16x16x32_bf16 v[244:247], a[112:115], a[128:131], v[244:247]
  s_add_u32 m0, s31, 131072
  s_nop 3
  v_cvt_pk_bf16_f32 v240, v240, v241
  s_waitcnt lgkmcnt(2)
  v_mfma_f32_16x16x32_bf16 v[248:251], a[118:121], a[132:135], 0
  v_cvt_pk_bf16_f32 v242, v242, v243
  v_accvgpr_write_b32 a128, v240
  v_mfma_f32_16x16x32_bf16 v[248:251], a[114:117], a[132:135], v[248:251]
  v_accvgpr_write_b32 a129, v242
  v_cvt_pk_bf16_f32 v244, v244, v245
  v_mfma_f32_16x16x32_bf16 v[252:255], a[116:119], a[132:135], 0
  v_cvt_pk_bf16_f32 v246, v246, v247
  v_accvgpr_write_b32 a130, v244
  v_mfma_f32_16x16x32_bf16 v[252:255], a[112:115], a[132:135], v[252:255]
  s_waitcnt lgkmcnt(1)
  v_accvgpr_write_b32 a131, v246
  s_nop 0
  v_cvt_pk_bf16_f32 v248, v248, v249
  v_mfma_f32_16x16x32_bf16 v[240:243], a[118:121], a[136:139], 0
  v_cvt_pk_bf16_f32 v250, v250, v251
  v_accvgpr_write_b32 a132, v248
  v_mfma_f32_16x16x32_bf16 v[240:243], a[114:117], a[136:139], v[240:243]
  v_accvgpr_write_b32 a133, v250
  v_cvt_pk_bf16_f32 v252, v252, v253
  v_mfma_f32_16x16x32_bf16 v[244:247], a[116:119], a[136:139], 0
  v_cvt_pk_bf16_f32 v254, v254, v255
  v_accvgpr_write_b32 a134, v252
  v_mfma_f32_16x16x32_bf16 v[244:247], a[112:115], a[136:139], v[244:247]
  s_waitcnt lgkmcnt(0)
  v_accvgpr_write_b32 a135, v254
  s_nop 0
  v_cvt_pk_bf16_f32 v240, v240, v241
  v_mfma_f32_16x16x32_bf16 v[248:251], a[118:121], a[140:143], 0
  v_cvt_pk_bf16_f32 v242, v242, v243
  v_accvgpr_write_b32 a136, v240
  v_mfma_f32_16x16x32_bf16 v[248:251], a[114:117], a[140:143], v[248:251]
  v_accvgpr_write_b32 a137, v242
  v_cvt_pk_bf16_f32 v244, v244, v245
  v_mfma_f32_16x16x32_bf16 v[252:255], a[116:119], a[140:143], 0
  v_cvt_pk_bf16_f32 v246, v246, v247
  v_accvgpr_write_b32 a138, v244
  v_mfma_f32_16x16x32_bf16 v[252:255], a[112:115], a[140:143], v[252:255]
  v_accvgpr_write_b32 a139, v246
  s_nop 0
  v_cvt_pk_bf16_f32 v248, v248, v249
  v_mfma_f32_16x16x32_bf16 v[64:67], v[128:131], a[128:131], 0
  v_cvt_pk_bf16_f32 v250, v250, v251
  v_accvgpr_write_b32 a140, v248
  v_mfma_f32_16x16x32_bf16 v[64:67], v[132:135], a[132:135], v[64:67]
  v_accvgpr_write_b32 a141, v250
  v_cvt_pk_bf16_f32 v252, v252, v253
  v_mfma_f32_16x16x32_bf16 v[64:67], v[136:139], a[136:139], v[64:67]
  v_cvt_pk_bf16_f32 v254, v254, v255
  v_accvgpr_write_b32 a142, v252
  v_accvgpr_write_b32 a143, v254
  s_nop 1
  v_mfma_f32_16x16x32_bf16 v[64:67], v[140:143], a[140:143], v[64:67]
  s_nop 7
  v_max3_f32 v48, v64, v65, v66
  v_max_f32 v48, v48, v67
  v_mov_b32 v49, v48
  s_nop 1
  v_permlane32_swap_b32 v48, v49
  v_max_f32 v48, v48, v49
  v_mov_b32 v49, v48
  s_nop 1
  v_permlane16_swap_b32 v48, v49
  v_max_f32 v48, v48, v49
  v_sub_f32 v49, s83, v48
  v_sub_f32 v50, s83, v48
  v_sub_f32 v51, s83, v48
  v_sub_f32 v48, s83, v48
  v_add_f32 v64, v64, v49
  v_add_f32 v65, v65, v49
  v_mfma_f32_16x16x32_bf16 v[224:227], v[144:147], a[128:131], v[48:51]
  s_waitcnt vmcnt(4)
  s_barrier
  buffer_load_dwordx4 v16, s[12:15], s34 offen sc1 nt lds
  buffer_load_dwordx4 v17, s[12:15], s34 offen offset:1024 sc1 nt lds
  v_mfma_f32_16x16x32_bf16 v[224:227], v[148:151], a[132:135], v[224:227]
  ds_read_b128 a[192:195], v4 offset:16384
  ds_read_b128 a[196:199], v5 offset:16384
  v_mfma_f32_16x16x32_bf16 v[224:227], v[152:155], a[136:139], v[224:227]
  ds_read_b128 a[200:203], v6 offset:16384
  ds_read_b128 a[204:207], v7 offset:16384
  v_mfma_f32_16x16x32_bf16 v[224:227], v[156:159], a[140:143], v[224:227]
  ds_read_b128 a[208:211], v4 offset:20480
  ds_read_b128 a[212:215], v5 offset:20480
  v_mfma_f32_16x16x32_bf16 v[68:71], v[160:163], a[128:131], v[48:51]
  ds_read_b128 a[216:219], v6 offset:20480
  buffer_load_dwordx4 v18, s[12:15], s34 offen offset:2048 sc1 nt lds
  v_mfma_f32_16x16x32_bf16 v[68:71], v[164:167], a[132:135], v[68:71]
  ds_read_b128 a[220:223], v7 offset:20480
  v_add_f32 v66, v66, v49
  v_mfma_f32_16x16x32_bf16 v[68:71], v[168:171], a[136:139], v[68:71]
  ds_read_b128 a[224:227], v4 offset:24576
  v_add_f32 v67, v67, v49
  v_mfma_f32_16x16x32_bf16 v[68:71], v[172:175], a[140:143], v[68:71]
  ds_read_b128 a[228:231], v5 offset:24576
  v_exp_f32 v64, v64
  v_mfma_f32_16x16x32_bf16 v[228:231], a[96:99], a[128:131], v[48:51]
  ds_read_b128 a[232:235], v6 offset:24576
  ds_read_b128 a[236:239], v7 offset:24576
  v_mfma_f32_16x16x32_bf16 v[228:231], a[100:103], a[132:135], v[228:231]
  buffer_load_dwordx4 v19, s[12:15], s34 offen offset:3072 sc1 nt lds
  v_mfma_f32_16x16x32_bf16 v[228:231], a[104:107], a[136:139], v[228:231]
  s_add_u32 m0, s31, 147456
  ds_read_b128 a[240:243], v4 offset:28672
  ds_read_b128 a[244:247], v5 offset:28672
  v_mfma_f32_16x16x32_bf16 v[228:231], a[108:111], a[140:143], v[228:231]
  s_waitcnt lgkmcnt(13)
  v_exp_f32 v65, v65
  v_mfma_f32_16x16x32_bf16 v[72:75], a[192:195], a[128:131], v[48:51]
  s_waitcnt lgkmcnt(11)
  ds_read_b128 a[248:251], v6 offset:28672
  ds_read_b128 a[252:255], v7 offset:28672
  v_mfma_f32_16x16x32_bf16 v[72:75], a[196:199], a[132:135], v[72:75]
  v_exp_f32 v66, v66
  v_mfma_f32_16x16x32_bf16 v[72:75], a[200:203], a[136:139], v[72:75]
  s_waitcnt lgkmcnt(10)
  ds_read_b64_tr_b16 v[176:177], v8 offset:0
  ds_read_b64_tr_b16 v[178:179], v8 offset:4096
  v_mfma_f32_16x16x32_bf16 v[72:75], a[204:207], a[140:143], v[72:75]
  ds_read_b64_tr_b16 v[180:181], v8 offset:8192
  ds_read_b64_tr_b16 v[182:183], v8 offset:12288
  v_mfma_f32_16x16x32_bf16 v[232:235], a[208:211], a[128:131], v[48:51]
  ds_read_b64_tr_b16 v[184:185], v9 offset:0
  ds_read_b64_tr_b16 v[186:187], v9 offset:4096
  v_mfma_f32_16x16x32_bf16 v[232:235], a[212:215], a[132:135], v[232:235]
  s_waitcnt lgkmcnt(13)
  ds_read_b64_tr_b16 v[188:189], v9 offset:8192
  ds_read_b64_tr_b16 v[190:191], v9 offset:12288
  v_mfma_f32_16x16x32_bf16 v[232:235], a[216:219], a[136:139], v[232:235]
  ds_read_b64_tr_b16 v[192:193], v10 offset:0
  ds_read_b64_tr_b16 v[194:195], v10 offset:4096
  v_mfma_f32_16x16x32_bf16 v[232:235], a[220:223], a[140:143], v[232:235]
  ds_read_b64_tr_b16 v[196:197], v10 offset:8192
  ds_read_b64_tr_b16 v[198:199], v10 offset:12288
  ds_read_b64_tr_b16 v[200:201], v11 offset:0
  ds_read_b64_tr_b16 v[202:203], v11 offset:4096
  v_mfma_f32_16x16x32_bf16 v[76:79], a[224:227], a[128:131], v[48:51]
  s_waitcnt lgkmcnt(15)
  ds_read_b64_tr_b16 v[204:205], v11 offset:8192
  ds_read_b64_tr_b16 v[206:207], v11 offset:12288
  v_mfma_f32_16x16x32_bf16 v[76:79], a[228:231], a[132:135], v[76:79]
  ds_read_b64_tr_b16 v[208:209], v12 offset:0
  ds_read_b64_tr_b16 v[210:211], v12 offset:4096
  v_mfma_f32_16x16x32_bf16 v[76:79], a[232:235], a[136:139], v[76:79]
  ds_read_b64_tr_b16 v[212:213], v12 offset:8192
  ds_read_b64_tr_b16 v[214:215], v12 offset:12288
  v_mfma_f32_16x16x32_bf16 v[76:79], a[236:239], a[140:143], v[76:79]
  ds_read_b64_tr_b16 v[216:217], v13 offset:0
  ds_read_b64_tr_b16 v[218:219], v13 offset:4096
  v_mfma_f32_16x16x32_bf16 v[236:239], a[240:243], a[128:131], v[48:51]
  ds_read_b64_tr_b16 v[220:221], v13 offset:8192
  ds_read_b64_tr_b16 v[222:223], v13 offset:12288
  v_mfma_f32_16x16x32_bf16 v[236:239], a[244:247], a[132:135], v[236:239]
  v_exp_f32 v72, v72
  v_mfma_f32_16x16x32_bf16 v[236:239], a[248:251], a[136:139], v[236:239]
  s_waitcnt lgkmcnt(15)
  v_exp_f32 v73, v73
  v_mfma_f32_16x16x32_bf16 v[236:239], a[252:255], a[140:143], v[236:239]
  v_exp_f32 v74, v74
  v_exp_f32 v75, v75
  v_exp_f32 v232, v232
  v_exp_f32 v233, v233
  v_exp_f32 v234, v234
  v_exp_f32 v235, v235
  v_cvt_pk_bf16_f32 v72, v72, v73
  v_cvt_pk_bf16_f32 v73, v74, v75
  v_exp_f32 v67, v67
  v_cvt_pk_bf16_f32 v74, v232, v233
  v_cvt_pk_bf16_f32 v75, v234, v235
  v_exp_f32 v224, v224
  v_exp_f32 v225, v225
  v_exp_f32 v226, v226
  v_exp_f32 v227, v227
  v_cvt_pk_bf16_f32 v64, v64, v65
  v_exp_f32 v68, v68
  v_exp_f32 v69, v69
  v_cvt_pk_bf16_f32 v65, v66, v67
  v_exp_f32 v70, v70
  v_exp_f32 v71, v71
  v_cvt_pk_bf16_f32 v66, v224, v225
  v_cvt_pk_bf16_f32 v67, v226, v227
  v_exp_f32 v228, v228
  v_exp_f32 v229, v229
  v_exp_f32 v230, v230
  v_exp_f32 v231, v231
  v_cvt_pk_bf16_f32 v68, v68, v69
  v_cvt_pk_bf16_f32 v69, v70, v71
  v_cvt_pk_bf16_f32 v70, v228, v229
  v_cvt_pk_bf16_f32 v71, v230, v231
  s_waitcnt lgkmcnt(0)
  v_mfma_f32_16x16x32_bf16 a[8:11], v[192:195], v[64:67], 0
  v_exp_f32 v76, v76
  v_mfma_f32_16x16x32_bf16 a[8:11], v[196:199], v[68:71], a[8:11]
  v_exp_f32 v77, v77
  v_mfma_f32_16x16x32_bf16 a[12:15], v[200:203], v[64:67], 0
  v_exp_f32 v78, v78
  v_mfma_f32_16x16x32_bf16 a[12:15], v[204:207], v[68:71], a[12:15]
  v_exp_f32 v79, v79
  v_exp_f32 v236, v236
  v_exp_f32 v237, v237
  v_exp_f32 v238, v238
  v_exp_f32 v239, v239
  v_cvt_pk_bf16_f32 v76, v76, v77
  v_cvt_pk_bf16_f32 v77, v78, v79
  v_cvt_pk_bf16_f32 v78, v236, v237
  v_cvt_pk_bf16_f32 v79, v238, v239
  v_mfma_f32_16x16x32_bf16 a[0:3], v[176:179], v[64:67], 0
  s_waitcnt vmcnt(4)
  ds_read_b128 a[144:147], v1 offset:16384
  ds_read_b128 a[148:151], v2 offset:16384
  ds_read_b128 a[152:155], v3 offset:16384
  ds_read_b128 a[156:159], v22 offset:16384
  buffer_load_dwordx4 v16, s[12:15], s35 offen sc1 nt lds
  buffer_load_dwordx4 v17, s[12:15], s35 offen offset:1024 sc1 nt lds
  v_mfma_f32_16x16x32_bf16 a[0:3], v[180:183], v[68:71], a[0:3]
  v_mfma_f32_16x16x32_bf16 a[16:19], v[208:211], v[64:67], 0
  v_mfma_f32_16x16x32_bf16 a[16:19], v[212:215], v[68:71], a[16:19]
  v_mfma_f32_16x16x32_bf16 a[20:23], v[216:219], v[64:67], 0
  buffer_load_dwordx4 v18, s[12:15], s35 offen offset:2048 sc1 nt lds
  v_mfma_f32_16x16x32_bf16 a[20:23], v[220:223], v[68:71], a[20:23]
  v_mfma_f32_16x16x32_bf16 a[4:7], v[184:187], v[64:67], 0
  s_waitcnt lgkmcnt(3)
  v_mfma_f32_16x16x32_bf16 v[240:243], a[118:121], a[144:147], 0
  v_mfma_f32_16x16x32_bf16 v[240:243], a[114:117], a[144:147], v[240:243]
  v_mfma_f32_16x16x32_bf16 v[244:247], a[116:119], a[144:147], 0
  buffer_load_dwordx4 v19, s[12:15], s35 offen offset:3072 sc1 nt lds
  v_mfma_f32_16x16x32_bf16 v[244:247], a[112:115], a[144:147], v[244:247]
  s_add_u32 m0, s31, 32768
  s_nop 3
  v_cvt_pk_bf16_f32 v240, v240, v241
  s_waitcnt lgkmcnt(2)
  v_mfma_f32_16x16x32_bf16 v[248:251], a[118:121], a[148:151], 0
  v_cvt_pk_bf16_f32 v242, v242, v243
  v_accvgpr_write_b32 a144, v240
  v_mfma_f32_16x16x32_bf16 v[248:251], a[114:117], a[148:151], v[248:251]
  v_accvgpr_write_b32 a145, v242
  v_cvt_pk_bf16_f32 v244, v244, v245
  v_mfma_f32_16x16x32_bf16 v[252:255], a[116:119], a[148:151], 0
  v_cvt_pk_bf16_f32 v246, v246, v247
  v_accvgpr_write_b32 a146, v244
  v_mfma_f32_16x16x32_bf16 v[252:255], a[112:115], a[148:151], v[252:255]
  s_waitcnt lgkmcnt(0)
  v_accvgpr_write_b32 a147, v246
  s_nop 0
  v_cvt_pk_bf16_f32 v248, v248, v249
  v_mfma_f32_16x16x32_bf16 v[240:243], a[118:121], a[152:155], 0
  v_cvt_pk_bf16_f32 v250, v250, v251
  v_accvgpr_write_b32 a148, v248
  v_mfma_f32_16x16x32_bf16 v[240:243], a[114:117], a[152:155], v[240:243]
  v_accvgpr_write_b32 a149, v250
  v_cvt_pk_bf16_f32 v252, v252, v253
  v_mfma_f32_16x16x32_bf16 v[244:247], a[116:119], a[152:155], 0
  v_cvt_pk_bf16_f32 v254, v254, v255
  v_accvgpr_write_b32 a150, v252
  v_mfma_f32_16x16x32_bf16 v[244:247], a[112:115], a[152:155], v[244:247]
  v_accvgpr_write_b32 a151, v254
  s_nop 0
  v_cvt_pk_bf16_f32 v240, v240, v241
  v_mfma_f32_16x16x32_bf16 v[248:251], a[118:121], a[156:159], 0
  v_cvt_pk_bf16_f32 v242, v242, v243
  v_accvgpr_write_b32 a152, v240
  v_mfma_f32_16x16x32_bf16 v[248:251], a[114:117], a[156:159], v[248:251]
  v_accvgpr_write_b32 a153, v242
  v_cvt_pk_bf16_f32 v244, v244, v245
  v_mfma_f32_16x16x32_bf16 v[252:255], a[116:119], a[156:159], 0
  v_cvt_pk_bf16_f32 v246, v246, v247
  v_accvgpr_write_b32 a154, v244
  v_mfma_f32_16x16x32_bf16 v[252:255], a[112:115], a[156:159], v[252:255]
  v_accvgpr_write_b32 a155, v246
  s_nop 0
  v_cvt_pk_bf16_f32 v248, v248, v249
  v_mfma_f32_16x16x32_bf16 v[80:83], v[128:131], a[144:147], 0
  v_cvt_pk_bf16_f32 v250, v250, v251
  v_accvgpr_write_b32 a156, v248
  v_mfma_f32_16x16x32_bf16 v[80:83], v[132:135], a[148:151], v[80:83]
  v_accvgpr_write_b32 a157, v250
  v_cvt_pk_bf16_f32 v252, v252, v253
  v_mfma_f32_16x16x32_bf16 v[80:83], v[136:139], a[152:155], v[80:83]
  v_cvt_pk_bf16_f32 v254, v254, v255
  v_accvgpr_write_b32 a158, v252
  v_accvgpr_write_b32 a159, v254
  v_mfma_f32_16x16x32_bf16 a[4:7], v[188:191], v[68:71], a[4:7]
  s_nop 0
  v_mfma_f32_16x16x32_bf16 v[80:83], v[140:143], a[156:159], v[80:83]
  v_smfmac_f32_16x16x64_bf16 v[32:35], v[24:27], v[64:71], v23
  v_smfmac_f32_16x16x64_bf16 v[32:35], v[24:27], v[72:79], v23
  s_nop 5
  v_max3_f32 v52, v80, v81, v82
  v_max_f32 v52, v52, v83
  v_mov_b32 v53, v52
  s_nop 1
  v_permlane32_swap_b32 v52, v53
  v_max_f32 v52, v52, v53
  v_mov_b32 v53, v52
  s_nop 1
  v_permlane16_swap_b32 v52, v53
  v_max_f32 v52, v52, v53
  v_sub_f32 v53, s83, v52
  v_sub_f32 v54, s83, v52
  v_sub_f32 v55, s83, v52
  v_sub_f32 v52, s83, v52
  v_add_f32 v80, v80, v53
  v_add_f32 v81, v81, v53
  v_mfma_f32_16x16x32_bf16 v[88:91], a[192:195], a[144:147], v[52:55]
  v_add_f32 v82, v82, v53
  v_add_f32 v83, v83, v53
  v_mfma_f32_16x16x32_bf16 v[88:91], a[196:199], a[148:151], v[88:91]
  v_exp_f32 v80, v80
  v_mfma_f32_16x16x32_bf16 v[88:91], a[200:203], a[152:155], v[88:91]
  v_exp_f32 v81, v81
  v_mfma_f32_16x16x32_bf16 v[88:91], a[204:207], a[156:159], v[88:91]
  v_exp_f32 v82, v82
  v_mfma_f32_16x16x32_bf16 v[232:235], a[208:211], a[144:147], v[52:55]
  v_exp_f32 v83, v83
  v_mfma_f32_16x16x32_bf16 v[232:235], a[212:215], a[148:151], v[232:235]
  v_cvt_pk_bf16_f32 v80, v80, v81
  s_nop 2
  v_exp_f32 v88, v88
  v_mfma_f32_16x16x32_bf16 v[232:235], a[216:219], a[152:155], v[232:235]
  v_exp_f32 v89, v89
  v_mfma_f32_16x16x32_bf16 v[232:235], a[220:223], a[156:159], v[232:235]
  v_exp_f32 v90, v90
  v_mfma_f32_16x16x32_bf16 v[224:227], v[144:147], a[144:147], v[52:55]
  v_exp_f32 v91, v91
  v_mfma_f32_16x16x32_bf16 v[224:227], v[148:151], a[148:151], v[224:227]
  v_cvt_pk_bf16_f32 v88, v88, v89
  s_nop 2
  v_exp_f32 v232, v232
  v_mfma_f32_16x16x32_bf16 v[224:227], v[152:155], a[152:155], v[224:227]
  v_exp_f32 v233, v233
  v_mfma_f32_16x16x32_bf16 v[224:227], v[156:159], a[156:159], v[224:227]
  v_exp_f32 v234, v234
  v_mfma_f32_16x16x32_bf16 v[84:87], v[160:163], a[144:147], v[52:55]
  v_exp_f32 v235, v235
  v_mfma_f32_16x16x32_bf16 v[84:87], v[164:167], a[148:151], v[84:87]
  v_cvt_pk_bf16_f32 v89, v90, v91
  v_cvt_pk_bf16_f32 v90, v232, v233
  v_mfma_f32_16x16x32_bf16 v[84:87], v[168:171], a[152:155], v[84:87]
  v_cvt_pk_bf16_f32 v91, v234, v235
  v_exp_f32 v224, v224
  v_mfma_f32_16x16x32_bf16 v[84:87], v[172:175], a[156:159], v[84:87]
  v_exp_f32 v225, v225
  v_mfma_f32_16x16x32_bf16 v[228:231], a[96:99], a[144:147], v[52:55]
  v_exp_f32 v226, v226
  v_mfma_f32_16x16x32_bf16 v[228:231], a[100:103], a[148:151], v[228:231]
  v_exp_f32 v227, v227
  v_mfma_f32_16x16x32_bf16 v[228:231], a[104:107], a[152:155], v[228:231]
  s_nop 1
  v_exp_f32 v84, v84
  v_mfma_f32_16x16x32_bf16 v[228:231], a[108:111], a[156:159], v[228:231]
  v_exp_f32 v85, v85
  v_mfma_f32_16x16x32_bf16 v[92:95], a[224:227], a[144:147], v[52:55]
  v_cvt_pk_bf16_f32 v81, v82, v83
  v_exp_f32 v86, v86
  v_mfma_f32_16x16x32_bf16 v[92:95], a[228:231], a[148:151], v[92:95]
  v_exp_f32 v87, v87
  v_mfma_f32_16x16x32_bf16 v[92:95], a[232:235], a[152:155], v[92:95]
  v_cvt_pk_bf16_f32 v82, v224, v225
  v_cvt_pk_bf16_f32 v83, v226, v227
  v_mfma_f32_16x16x32_bf16 v[92:95], a[236:239], a[156:159], v[92:95]
  v_exp_f32 v228, v228
  v_mfma_f32_16x16x32_bf16 v[236:239], a[240:243], a[144:147], v[52:55]
  v_exp_f32 v229, v229
  v_mfma_f32_16x16x32_bf16 v[236:239], a[244:247], a[148:151], v[236:239]
  v_exp_f32 v230, v230
  v_mfma_f32_16x16x32_bf16 v[236:239], a[248:251], a[152:155], v[236:239]
  v_exp_f32 v231, v231
  v_mfma_f32_16x16x32_bf16 v[236:239], a[252:255], a[156:159], v[236:239]
  v_cvt_pk_bf16_f32 v84, v84, v85
  v_cvt_pk_bf16_f32 v85, v86, v87
  v_mfma_f32_16x16x32_bf16 a[40:43], v[192:195], v[80:83], 0
  v_cvt_pk_bf16_f32 v86, v228, v229
  v_cvt_pk_bf16_f32 v87, v230, v231
  v_mfma_f32_16x16x32_bf16 a[44:47], v[200:203], v[80:83], 0
  v_exp_f32 v92, v92
  v_mfma_f32_16x16x32_bf16 a[44:47], v[204:207], v[84:87], a[44:47]
  v_exp_f32 v93, v93
  v_mfma_f32_16x16x32_bf16 a[40:43], v[196:199], v[84:87], a[40:43]
  v_exp_f32 v94, v94
  v_mfma_f32_16x16x32_bf16 a[32:35], v[176:179], v[80:83], 0
  v_exp_f32 v95, v95
  v_mfma_f32_16x16x32_bf16 a[32:35], v[180:183], v[84:87], a[32:35]
  v_exp_f32 v236, v236
  v_mfma_f32_16x16x32_bf16 a[48:51], v[208:211], v[80:83], 0
  v_exp_f32 v237, v237
  v_mfma_f32_16x16x32_bf16 a[48:51], v[212:215], v[84:87], a[48:51]
  v_exp_f32 v238, v238
  s_waitcnt vmcnt(4)
  ds_read_b128 a[160:163], v1 offset:32768
  ds_read_b128 a[164:167], v2 offset:32768
  ds_read_b128 a[168:171], v3 offset:32768
  ds_read_b128 a[172:175], v22 offset:32768
  buffer_load_dwordx4 v16, s[16:19], s42 offen sc1 nt lds
  buffer_load_dwordx4 v17, s[16:19], s42 offen offset:1024 sc1 nt lds
  v_mfma_f32_16x16x32_bf16 a[52:55], v[216:219], v[80:83], 0
  v_exp_f32 v239, v239
  v_mfma_f32_16x16x32_bf16 a[52:55], v[220:223], v[84:87], a[52:55]
  v_cvt_pk_bf16_f32 v92, v92, v93
  v_cvt_pk_bf16_f32 v93, v94, v95
  v_cvt_pk_bf16_f32 v94, v236, v237
  v_cvt_pk_bf16_f32 v95, v238, v239
  v_mfma_f32_16x16x32_bf16 a[36:39], v[184:187], v[80:83], 0
  v_mfma_f32_16x16x32_bf16 a[36:39], v[188:191], v[84:87], a[36:39]
  buffer_load_dwordx4 v18, s[16:19], s42 offen offset:2048 sc1 nt lds
  v_smfmac_f32_16x16x64_bf16 v[36:39], v[24:27], v[80:87], v23
  v_smfmac_f32_16x16x64_bf16 v[36:39], v[24:27], v[88:95], v23
  s_waitcnt lgkmcnt(3)
  v_mfma_f32_16x16x32_bf16 v[240:243], a[118:121], a[160:163], 0
  v_mfma_f32_16x16x32_bf16 v[240:243], a[114:117], a[160:163], v[240:243]
  v_mfma_f32_16x16x32_bf16 v[244:247], a[116:119], a[160:163], 0
  buffer_load_dwordx4 v19, s[16:19], s42 offen offset:3072 sc1 nt lds
  v_mfma_f32_16x16x32_bf16 v[244:247], a[112:115], a[160:163], v[244:247]
  s_waitcnt lgkmcnt(2)
  s_add_u32 m0, s31, 49152
  s_mov_b32 s42, 49152
  s_nop 2
  v_cvt_pk_bf16_f32 v240, v240, v241
  v_mfma_f32_16x16x32_bf16 v[248:251], a[118:121], a[164:167], 0
  v_cvt_pk_bf16_f32 v242, v242, v243
  v_accvgpr_write_b32 a160, v240
  v_mfma_f32_16x16x32_bf16 v[248:251], a[114:117], a[164:167], v[248:251]
  v_accvgpr_write_b32 a161, v242
  v_cvt_pk_bf16_f32 v244, v244, v245
  v_mfma_f32_16x16x32_bf16 v[252:255], a[116:119], a[164:167], 0
  v_cvt_pk_bf16_f32 v246, v246, v247
  v_accvgpr_write_b32 a162, v244
  v_mfma_f32_16x16x32_bf16 v[252:255], a[112:115], a[164:167], v[252:255]
  s_waitcnt lgkmcnt(0)
  v_accvgpr_write_b32 a163, v246
  s_nop 0
  v_cvt_pk_bf16_f32 v248, v248, v249
  v_mfma_f32_16x16x32_bf16 v[240:243], a[118:121], a[168:171], 0
  v_cvt_pk_bf16_f32 v250, v250, v251
  v_accvgpr_write_b32 a164, v248
  v_mfma_f32_16x16x32_bf16 v[240:243], a[114:117], a[168:171], v[240:243]
  v_accvgpr_write_b32 a165, v250
  v_cvt_pk_bf16_f32 v252, v252, v253
  v_mfma_f32_16x16x32_bf16 v[244:247], a[116:119], a[168:171], 0
  v_cvt_pk_bf16_f32 v254, v254, v255
  v_accvgpr_write_b32 a166, v252
  v_mfma_f32_16x16x32_bf16 v[244:247], a[112:115], a[168:171], v[244:247]
  v_accvgpr_write_b32 a167, v254
  s_nop 0
  v_cvt_pk_bf16_f32 v240, v240, v241
  v_mfma_f32_16x16x32_bf16 v[248:251], a[118:121], a[172:175], 0
  v_cvt_pk_bf16_f32 v242, v242, v243
  v_accvgpr_write_b32 a168, v240
  v_mfma_f32_16x16x32_bf16 v[248:251], a[114:117], a[172:175], v[248:251]
  v_accvgpr_write_b32 a169, v242
  v_cvt_pk_bf16_f32 v244, v244, v245
  v_mfma_f32_16x16x32_bf16 v[252:255], a[116:119], a[172:175], 0
  v_cvt_pk_bf16_f32 v246, v246, v247
  v_accvgpr_write_b32 a170, v244
  v_mfma_f32_16x16x32_bf16 v[252:255], a[112:115], a[172:175], v[252:255]
  v_accvgpr_write_b32 a171, v246
  s_nop 0
  v_cvt_pk_bf16_f32 v248, v248, v249
  v_mfma_f32_16x16x32_bf16 v[96:99], v[128:131], a[160:163], 0
  v_cvt_pk_bf16_f32 v250, v250, v251
  v_accvgpr_write_b32 a172, v248
  v_mfma_f32_16x16x32_bf16 v[96:99], v[132:135], a[164:167], v[96:99]
  v_accvgpr_write_b32 a173, v250
  v_cvt_pk_bf16_f32 v252, v252, v253
  v_mfma_f32_16x16x32_bf16 v[96:99], v[136:139], a[168:171], v[96:99]
  v_cvt_pk_bf16_f32 v254, v254, v255
  v_accvgpr_write_b32 a174, v252
  v_accvgpr_write_b32 a175, v254
  s_nop 1
  v_mfma_f32_16x16x32_bf16 v[96:99], v[140:143], a[172:175], v[96:99]
  s_nop 7
  v_max3_f32 v56, v96, v97, v98
  v_max_f32 v56, v56, v99
  v_mov_b32 v57, v56
  s_nop 1
  v_permlane32_swap_b32 v56, v57
  v_max_f32 v56, v56, v57
  v_mov_b32 v57, v56
  s_nop 1
  v_permlane16_swap_b32 v56, v57
  v_max_f32 v56, v56, v57
  v_sub_f32 v57, s83, v56
  v_sub_f32 v58, s83, v56
  v_sub_f32 v59, s83, v56
  v_sub_f32 v56, s83, v56
  v_add_f32 v96, v96, v57
  v_add_f32 v97, v97, v57
  v_mfma_f32_16x16x32_bf16 v[104:107], a[192:195], a[160:163], v[56:59]
  v_add_f32 v98, v98, v57
  v_add_f32 v99, v99, v57
  v_mfma_f32_16x16x32_bf16 v[104:107], a[196:199], a[164:167], v[104:107]
  v_exp_f32 v96, v96
  v_mfma_f32_16x16x32_bf16 v[104:107], a[200:203], a[168:171], v[104:107]
  v_exp_f32 v97, v97
  v_mfma_f32_16x16x32_bf16 v[104:107], a[204:207], a[172:175], v[104:107]
  v_exp_f32 v98, v98
  v_mfma_f32_16x16x32_bf16 v[232:235], a[208:211], a[160:163], v[56:59]
  v_exp_f32 v99, v99
  v_mfma_f32_16x16x32_bf16 v[232:235], a[212:215], a[164:167], v[232:235]
  v_cvt_pk_bf16_f32 v96, v96, v97
  s_nop 2
  v_exp_f32 v104, v104
  v_mfma_f32_16x16x32_bf16 v[232:235], a[216:219], a[168:171], v[232:235]
  v_exp_f32 v105, v105
  v_mfma_f32_16x16x32_bf16 v[232:235], a[220:223], a[172:175], v[232:235]
  v_exp_f32 v106, v106
  v_mfma_f32_16x16x32_bf16 v[224:227], v[144:147], a[160:163], v[56:59]
  v_exp_f32 v107, v107
  v_mfma_f32_16x16x32_bf16 v[224:227], v[148:151], a[164:167], v[224:227]
  v_cvt_pk_bf16_f32 v104, v104, v105
  s_nop 2
  v_exp_f32 v232, v232
  v_mfma_f32_16x16x32_bf16 v[224:227], v[152:155], a[168:171], v[224:227]
  v_exp_f32 v233, v233
  v_mfma_f32_16x16x32_bf16 v[224:227], v[156:159], a[172:175], v[224:227]
  v_exp_f32 v234, v234
  v_mfma_f32_16x16x32_bf16 v[100:103], v[160:163], a[160:163], v[56:59]
  v_exp_f32 v235, v235
  v_mfma_f32_16x16x32_bf16 v[100:103], v[164:167], a[164:167], v[100:103]
  v_cvt_pk_bf16_f32 v105, v106, v107
  v_cvt_pk_bf16_f32 v106, v232, v233
  v_mfma_f32_16x16x32_bf16 v[100:103], v[168:171], a[168:171], v[100:103]
  v_cvt_pk_bf16_f32 v107, v234, v235
  v_exp_f32 v224, v224
  v_mfma_f32_16x16x32_bf16 v[100:103], v[172:175], a[172:175], v[100:103]
  v_exp_f32 v225, v225
  v_mfma_f32_16x16x32_bf16 v[228:231], a[96:99], a[160:163], v[56:59]
  v_exp_f32 v226, v226
  v_mfma_f32_16x16x32_bf16 v[228:231], a[100:103], a[164:167], v[228:231]
  v_exp_f32 v227, v227
  v_mfma_f32_16x16x32_bf16 v[228:231], a[104:107], a[168:171], v[228:231]
  s_nop 1
  v_exp_f32 v100, v100
  v_mfma_f32_16x16x32_bf16 v[228:231], a[108:111], a[172:175], v[228:231]
  v_exp_f32 v101, v101
  v_mfma_f32_16x16x32_bf16 v[108:111], a[224:227], a[160:163], v[56:59]
  v_cvt_pk_bf16_f32 v97, v98, v99
  v_exp_f32 v102, v102
  v_mfma_f32_16x16x32_bf16 v[108:111], a[228:231], a[164:167], v[108:111]
  v_exp_f32 v103, v103
  v_mfma_f32_16x16x32_bf16 v[108:111], a[232:235], a[168:171], v[108:111]
  v_cvt_pk_bf16_f32 v98, v224, v225
  v_cvt_pk_bf16_f32 v99, v226, v227
  v_mfma_f32_16x16x32_bf16 v[108:111], a[236:239], a[172:175], v[108:111]
  v_exp_f32 v228, v228
  v_mfma_f32_16x16x32_bf16 v[236:239], a[240:243], a[160:163], v[56:59]
  v_exp_f32 v229, v229
  v_mfma_f32_16x16x32_bf16 v[236:239], a[244:247], a[164:167], v[236:239]
  v_exp_f32 v230, v230
  v_mfma_f32_16x16x32_bf16 v[236:239], a[248:251], a[168:171], v[236:239]
  v_exp_f32 v231, v231
  v_mfma_f32_16x16x32_bf16 v[236:239], a[252:255], a[172:175], v[236:239]
  v_cvt_pk_bf16_f32 v100, v100, v101
  v_cvt_pk_bf16_f32 v101, v102, v103
  v_mfma_f32_16x16x32_bf16 a[72:75], v[192:195], v[96:99], 0
  v_cvt_pk_bf16_f32 v102, v228, v229
  v_cvt_pk_bf16_f32 v103, v230, v231
  v_mfma_f32_16x16x32_bf16 a[76:79], v[200:203], v[96:99], 0
  v_exp_f32 v108, v108
  v_mfma_f32_16x16x32_bf16 a[76:79], v[204:207], v[100:103], a[76:79]
  v_exp_f32 v109, v109
  v_mfma_f32_16x16x32_bf16 a[72:75], v[196:199], v[100:103], a[72:75]
  v_exp_f32 v110, v110
  v_mfma_f32_16x16x32_bf16 a[64:67], v[176:179], v[96:99], 0
  v_exp_f32 v111, v111
  v_mfma_f32_16x16x32_bf16 a[64:67], v[180:183], v[100:103], a[64:67]
  v_exp_f32 v236, v236
  v_mfma_f32_16x16x32_bf16 a[80:83], v[208:211], v[96:99], 0
  v_exp_f32 v237, v237
  v_mfma_f32_16x16x32_bf16 a[80:83], v[212:215], v[100:103], a[80:83]
  v_exp_f32 v238, v238
  v_mfma_f32_16x16x32_bf16 a[84:87], v[216:219], v[96:99], 0
  s_waitcnt vmcnt(4)
  ds_read_b128 a[176:179], v1 offset:49152
  ds_read_b128 a[180:183], v2 offset:49152
  ds_read_b128 a[184:187], v3 offset:49152
  ds_read_b128 a[188:191], v22 offset:49152
  buffer_load_dwordx4 v16, s[16:19], s42 offen sc1 nt lds
  v_mfma_f32_16x16x32_bf16 a[84:87], v[220:223], v[100:103], a[84:87]
  buffer_load_dwordx4 v17, s[16:19], s42 offen offset:1024 sc1 nt lds
  v_mfma_f32_16x16x32_bf16 a[68:71], v[184:187], v[96:99], 0
  v_exp_f32 v239, v239
  v_mfma_f32_16x16x32_bf16 a[68:71], v[188:191], v[100:103], a[68:71]
  v_cvt_pk_bf16_f32 v108, v108, v109
  v_cvt_pk_bf16_f32 v109, v110, v111
  v_cvt_pk_bf16_f32 v110, v236, v237
  v_cvt_pk_bf16_f32 v111, v238, v239
  v_smfmac_f32_16x16x64_bf16 v[40:43], v[24:27], v[96:103], v23
  buffer_load_dwordx4 v18, s[16:19], s42 offen offset:2048 sc1 nt lds
  v_smfmac_f32_16x16x64_bf16 v[40:43], v[24:27], v[104:111], v23
  s_waitcnt lgkmcnt(3)
  v_mfma_f32_16x16x32_bf16 v[240:243], a[118:121], a[176:179], 0
L_pad1:
  s_cbranch_execz L_pad5
  v_mfma_f32_16x16x32_bf16 v[240:243], a[114:117], a[176:179], v[240:243]
  v_mfma_f32_16x16x32_bf16 v[244:247], a[116:119], a[176:179], 0
  buffer_load_dwordx4 v19, s[16:19], s42 offen offset:3072 sc1 nt lds
  v_mfma_f32_16x16x32_bf16 v[244:247], a[112:115], a[176:179], v[244:247]
  s_waitcnt lgkmcnt(2)
  s_add_u32 m0, s32, 16384
  s_mov_b32 s42, 16384
  s_nop 2
  v_cvt_pk_bf16_f32 v240, v240, v241
  v_mfma_f32_16x16x32_bf16 v[248:251], a[118:121], a[180:183], 0
  v_cvt_pk_bf16_f32 v242, v242, v243
  v_accvgpr_write_b32 a176, v240
  v_mfma_f32_16x16x32_bf16 v[248:251], a[114:117], a[180:183], v[248:251]
  v_accvgpr_write_b32 a177, v242
  v_cvt_pk_bf16_f32 v244, v244, v245
  v_mfma_f32_16x16x32_bf16 v[252:255], a[116:119], a[180:183], 0
  v_cvt_pk_bf16_f32 v246, v246, v247
  v_accvgpr_write_b32 a178, v244
  v_mfma_f32_16x16x32_bf16 v[252:255], a[112:115], a[180:183], v[252:255]
  s_waitcnt lgkmcnt(0)
  v_accvgpr_write_b32 a179, v246
  s_nop 0
  v_cvt_pk_bf16_f32 v248, v248, v249
  v_mfma_f32_16x16x32_bf16 v[240:243], a[118:121], a[184:187], 0
  v_cvt_pk_bf16_f32 v250, v250, v251
  v_accvgpr_write_b32 a180, v248
  v_mfma_f32_16x16x32_bf16 v[240:243], a[114:117], a[184:187], v[240:243]
  v_accvgpr_write_b32 a181, v250
  v_cvt_pk_bf16_f32 v252, v252, v253
  v_mfma_f32_16x16x32_bf16 v[244:247], a[116:119], a[184:187], 0
  v_cvt_pk_bf16_f32 v254, v254, v255
  v_accvgpr_write_b32 a182, v252
  v_mfma_f32_16x16x32_bf16 v[244:247], a[112:115], a[184:187], v[244:247]
  v_accvgpr_write_b32 a183, v254
  s_nop 0
  v_cvt_pk_bf16_f32 v240, v240, v241
  v_mfma_f32_16x16x32_bf16 v[248:251], a[118:121], a[188:191], 0
  v_cvt_pk_bf16_f32 v242, v242, v243
  v_accvgpr_write_b32 a184, v240
  v_mfma_f32_16x16x32_bf16 v[248:251], a[114:117], a[188:191], v[248:251]
  v_accvgpr_write_b32 a185, v242
  v_cvt_pk_bf16_f32 v244, v244, v245
  v_mfma_f32_16x16x32_bf16 v[252:255], a[116:119], a[188:191], 0
  v_cvt_pk_bf16_f32 v246, v246, v247
  v_accvgpr_write_b32 a186, v244
  v_mfma_f32_16x16x32_bf16 v[252:255], a[112:115], a[188:191], v[252:255]
  v_accvgpr_write_b32 a187, v246
  s_nop 0
  v_cvt_pk_bf16_f32 v248, v248, v249
  v_mfma_f32_16x16x32_bf16 v[112:115], v[128:131], a[176:179], 0
  v_cvt_pk_bf16_f32 v250, v250, v251
  v_accvgpr_write_b32 a188, v248
  v_mfma_f32_16x16x32_bf16 v[112:115], v[132:135], a[180:183], v[112:115]
  v_accvgpr_write_b32 a189, v250
  v_cvt_pk_bf16_f32 v252, v252, v253
  v_mfma_f32_16x16x32_bf16 v[112:115], v[136:139], a[184:187], v[112:115]
  v_cvt_pk_bf16_f32 v254, v254, v255
  v_accvgpr_write_b32 a190, v252
  v_accvgpr_write_b32 a191, v254
  s_nop 1
  v_mfma_f32_16x16x32_bf16 v[112:115], v[140:143], a[188:191], v[112:115]
  buffer_load_dwordx4 v20, s[20:23], s42 offen sc1 nt lds
  buffer_load_dwordx4 v21, s[20:23], s42 offen offset:1024 sc1 nt lds
  s_nop 5
  v_max3_f32 v60, v112, v113, v114
  v_max_f32 v60, v60, v115
  v_mov_b32 v61, v60
  s_nop 1
  v_permlane32_swap_b32 v60, v61
  v_max_f32 v60, v60, v61
  v_mov_b32 v61, v60
  s_nop 1
  v_permlane16_swap_b32 v60, v61
  v_max_f32 v60, v60, v61
  v_sub_f32 v61, s83, v60
  v_sub_f32 v62, s83, v60
  v_sub_f32 v63, s83, v60
  v_sub_f32 v60, s83, v60
  v_add_f32 v112, v112, v61
  v_add_f32 v113, v113, v61
  v_mfma_f32_16x16x32_bf16 v[120:123], a[192:195], a[176:179], v[60:63]
  buffer_load_dwordx4 v20, s[20:23], s42 offen offset:2048 sc1 nt lds
  v_mfma_f32_16x16x32_bf16 v[120:123], a[196:199], a[180:183], v[120:123]
  v_add_f32 v114, v114, v61
  v_add_f32 v115, v115, v61
  v_mfma_f32_16x16x32_bf16 v[120:123], a[200:203], a[184:187], v[120:123]
  buffer_load_dwordx4 v21, s[20:23], s42 offen offset:3072 sc1 nt lds
  v_mfma_f32_16x16x32_bf16 v[120:123], a[204:207], a[188:191], v[120:123]
  s_waitcnt vmcnt(8)
  s_barrier
  ds_read_b128 a[204:207], v7 offset:32768
  v_mfma_f32_16x16x32_bf16 v[232:235], a[208:211], a[176:179], v[60:63]
  s_add_u32 m0, s32, 32768
  ds_read_b128 a[200:203], v6 offset:32768
  ds_read_b128 a[192:195], v4 offset:32768
  v_mfma_f32_16x16x32_bf16 v[232:235], a[212:215], a[180:183], v[232:235]
  s_mov_b32 s42, 32768
  ds_read_b128 a[196:199], v5 offset:32768
  ds_read_b128 a[208:211], v4 offset:36864
  v_mfma_f32_16x16x32_bf16 v[232:235], a[216:219], a[184:187], v[232:235]
  ds_read_b128 a[216:219], v6 offset:36864
  ds_read_b128 a[212:215], v5 offset:36864
  v_mfma_f32_16x16x32_bf16 v[232:235], a[220:223], a[188:191], v[232:235]
  v_exp_f32 v112, v112
  v_mfma_f32_16x16x32_bf16 v[224:227], v[144:147], a[176:179], v[60:63]
  ds_read_b128 a[220:223], v7 offset:36864
  v_exp_f32 v113, v113
  v_mfma_f32_16x16x32_bf16 v[224:227], v[148:151], a[180:183], v[224:227]
  v_exp_f32 v114, v114
  v_mfma_f32_16x16x32_bf16 v[224:227], v[152:155], a[184:187], v[224:227]
  v_exp_f32 v115, v115
  v_mfma_f32_16x16x32_bf16 v[224:227], v[156:159], a[188:191], v[224:227]
  v_cvt_pk_bf16_f32 v112, v112, v113
  v_cvt_pk_bf16_f32 v113, v114, v115
  v_mfma_f32_16x16x32_bf16 v[116:119], v[160:163], a[176:179], v[60:63]
  v_exp_f32 v120, v120
  v_mfma_f32_16x16x32_bf16 v[116:119], v[164:167], a[180:183], v[116:119]
  v_exp_f32 v121, v121
  v_mfma_f32_16x16x32_bf16 v[116:119], v[168:171], a[184:187], v[116:119]
  s_nop 0
  v_exp_f32 v224, v224
  v_mfma_f32_16x16x32_bf16 v[116:119], v[172:175], a[188:191], v[116:119]
  v_exp_f32 v225, v225
  v_mfma_f32_16x16x32_bf16 v[228:231], a[96:99], a[176:179], v[60:63]
  v_exp_f32 v226, v226
  v_mfma_f32_16x16x32_bf16 v[228:231], a[100:103], a[180:183], v[228:231]
  v_exp_f32 v227, v227
  v_mfma_f32_16x16x32_bf16 v[228:231], a[104:107], a[184:187], v[228:231]
  s_nop 1
  v_exp_f32 v116, v116
  v_mfma_f32_16x16x32_bf16 v[228:231], a[108:111], a[188:191], v[228:231]
  v_exp_f32 v117, v117
  v_mfma_f32_16x16x32_bf16 v[124:127], a[224:227], a[176:179], v[60:63]
  ds_read_b128 a[224:227], v4 offset:40960
  v_exp_f32 v118, v118
  v_mfma_f32_16x16x32_bf16 v[124:127], a[228:231], a[180:183], v[124:127]
  ds_read_b128 a[228:231], v5 offset:40960
  v_exp_f32 v119, v119
  v_mfma_f32_16x16x32_bf16 v[124:127], a[232:235], a[184:187], v[124:127]
  ds_read_b128 a[232:235], v6 offset:40960
  v_cvt_pk_bf16_f32 v114, v224, v225
  v_mfma_f32_16x16x32_bf16 v[124:127], a[236:239], a[188:191], v[124:127]
  ds_read_b128 a[236:239], v7 offset:40960
  v_cvt_pk_bf16_f32 v115, v226, v227
  v_mfma_f32_16x16x32_bf16 v[236:239], a[240:243], a[176:179], v[60:63]
  ds_read_b128 a[240:243], v4 offset:45056
  v_exp_f32 v228, v228
  v_mfma_f32_16x16x32_bf16 v[236:239], a[244:247], a[180:183], v[236:239]
  ds_read_b128 a[244:247], v5 offset:45056
  v_exp_f32 v229, v229
  v_mfma_f32_16x16x32_bf16 v[236:239], a[248:251], a[184:187], v[236:239]
  ds_read_b128 a[248:251], v6 offset:45056
  v_exp_f32 v230, v230
  v_mfma_f32_16x16x32_bf16 v[236:239], a[252:255], a[188:191], v[236:239]
  ds_read_b128 a[252:255], v7 offset:45056
  buffer_load_dwordx4 v20, s[20:23], s42 offen sc1 nt lds
  v_mfma_f32_16x16x32_bf16 a[104:107], v[192:195], v[112:115], 0
  buffer_load_dwordx4 v21, s[20:23], s42 offen offset:1024 sc1 nt lds
  v_mfma_f32_16x16x32_bf16 a[108:111], v[200:203], v[112:115], 0
  s_waitcnt lgkmcnt(8)
  v_exp_f32 v231, v231
  v_mfma_f32_16x16x32_bf16 v[160:163], a[204:207], a[172:175], v[56:59]
  v_cvt_pk_bf16_f32 v116, v116, v117
  v_cvt_pk_bf16_f32 v117, v118, v119
  v_mfma_f32_16x16x32_bf16 v[160:163], a[200:203], a[168:171], v[160:163]
  v_cvt_pk_bf16_f32 v118, v228, v229
  v_cvt_pk_bf16_f32 v119, v230, v231
  v_mfma_f32_16x16x32_bf16 v[160:163], a[196:199], a[164:167], v[160:163]
  buffer_load_dwordx4 v20, s[20:23], s42 offen offset:2048 sc1 nt lds
  v_mfma_f32_16x16x32_bf16 v[160:163], a[192:195], a[160:163], v[160:163]
  v_exp_f32 v122, v122
  v_mfma_f32_16x16x32_bf16 a[104:107], v[196:199], v[116:119], a[104:107]
  v_exp_f32 v123, v123
  v_mfma_f32_16x16x32_bf16 a[108:111], v[204:207], v[116:119], a[108:111]
  v_exp_f32 v232, v232
  v_mfma_f32_16x16x32_bf16 v[128:131], a[204:207], a[140:143], v[48:51]
  v_exp_f32 v233, v233
  v_mfma_f32_16x16x32_bf16 v[128:131], a[200:203], a[136:139], v[128:131]
  buffer_load_dwordx4 v21, s[20:23], s42 offen offset:3072 sc1 nt lds
  v_mfma_f32_16x16x32_bf16 v[128:131], a[196:199], a[132:135], v[128:131]
  s_add_u32 m0, s32, 49152
  v_exp_f32 v234, v234
  v_mfma_f32_16x16x32_bf16 v[128:131], a[192:195], a[128:131], v[128:131]
  s_mov_b32 s42, 49152
  v_exp_f32 v235, v235
  v_mfma_f32_16x16x32_bf16 v[196:199], a[220:223], a[156:159], v[52:55]
  v_cvt_pk_bf16_f32 v120, v120, v121
  v_cvt_pk_bf16_f32 v121, v122, v123
  v_mfma_f32_16x16x32_bf16 v[196:199], a[216:219], a[152:155], v[196:199]
  v_cvt_pk_bf16_f32 v122, v232, v233
  v_cvt_pk_bf16_f32 v123, v234, v235
  v_mfma_f32_16x16x32_bf16 v[196:199], a[212:215], a[148:151], v[196:199]
  v_exp_f32 v124, v124
  v_mfma_f32_16x16x32_bf16 v[196:199], a[208:211], a[144:147], v[196:199]
  v_exp_f32 v125, v125
  v_mfma_f32_16x16x32_bf16 v[204:207], a[220:223], a[188:191], v[60:63]
  v_exp_f32 v126, v126
  v_mfma_f32_16x16x32_bf16 v[204:207], a[216:219], a[184:187], v[204:207]
  v_exp_f32 v127, v127
  v_mfma_f32_16x16x32_bf16 v[204:207], a[212:215], a[180:183], v[204:207]
  v_exp_f32 v236, v236
  v_mfma_f32_16x16x32_bf16 v[204:207], a[208:211], a[176:179], v[204:207]
  v_exp_f32 v237, v237
  v_mfma_f32_16x16x32_bf16 a[96:99], v[176:179], v[112:115], 0
  v_exp_f32 v238, v238
  v_mfma_f32_16x16x32_bf16 v[176:179], a[192:195], a[176:179], v[60:63]
  v_exp_f32 v239, v239
  v_mfma_f32_16x16x32_bf16 v[176:179], a[196:199], a[180:183], v[176:179]
  v_cvt_pk_bf16_f32 v124, v124, v125
  v_cvt_pk_bf16_f32 v125, v126, v127
  v_mfma_f32_16x16x32_bf16 v[176:179], a[200:203], a[184:187], v[176:179]
  v_cvt_pk_bf16_f32 v126, v236, v237
  v_cvt_pk_bf16_f32 v127, v238, v239
  v_mfma_f32_16x16x32_bf16 v[176:179], a[204:207], a[188:191], v[176:179]
  v_exp_f32 v128, v128
  v_mfma_f32_16x16x32_bf16 v[144:147], a[192:195], a[144:147], v[52:55]
  v_exp_f32 v129, v129
  v_mfma_f32_16x16x32_bf16 v[144:147], a[196:199], a[148:151], v[144:147]
  s_waitcnt vmcnt(4)
  v_mfma_f32_16x16x32_bf16 v[144:147], a[200:203], a[152:155], v[144:147]
  s_barrier
  ds_read_b128 a[192:195], v4 offset:49152
  ds_read_b128 a[196:199], v5 offset:49152
  v_mfma_f32_16x16x32_bf16 v[144:147], a[204:207], a[156:159], v[144:147]
  ds_read_b128 a[200:203], v6 offset:49152
  ds_read_b128 a[204:207], v7 offset:49152
  v_mfma_f32_16x16x32_bf16 v[192:195], a[208:211], a[128:131], v[48:51]
  buffer_load_dwordx4 v20, s[20:23], s42 offen sc1 nt lds
  v_mfma_f32_16x16x32_bf16 v[192:195], a[212:215], a[132:135], v[192:195]
  buffer_load_dwordx4 v21, s[20:23], s42 offen offset:1024 sc1 nt lds
  v_mfma_f32_16x16x32_bf16 v[192:195], a[216:219], a[136:139], v[192:195]
  v_exp_f32 v130, v130
  v_mfma_f32_16x16x32_bf16 v[192:195], a[220:223], a[140:143], v[192:195]
  v_exp_f32 v131, v131
  v_mfma_f32_16x16x32_bf16 v[200:203], a[208:211], a[160:163], v[56:59]
  ds_read_b128 a[208:211], v4 offset:53248
  v_mfma_f32_16x16x32_bf16 v[200:203], a[212:215], a[164:167], v[200:203]
  ds_read_b128 a[212:215], v5 offset:53248
  buffer_load_dwordx4 v20, s[20:23], s42 offen offset:2048 sc1 nt lds
  v_mfma_f32_16x16x32_bf16 v[200:203], a[216:219], a[168:171], v[200:203]
  ds_read_b128 a[216:219], v6 offset:53248
  v_exp_f32 v192, v192
  v_mfma_f32_16x16x32_bf16 v[200:203], a[220:223], a[172:175], v[200:203]
  ds_read_b128 a[220:223], v7 offset:53248
  v_exp_f32 v193, v193
  v_mfma_f32_16x16x32_bf16 a[112:115], v[208:211], v[112:115], 0
  v_exp_f32 v194, v194
  v_mfma_f32_16x16x32_bf16 a[112:115], v[212:215], v[116:119], a[112:115]
  v_exp_f32 v195, v195
  v_mfma_f32_16x16x32_bf16 a[116:119], v[216:219], v[112:115], 0
  buffer_load_dwordx4 v21, s[20:23], s42 offen offset:3072 sc1 nt lds
  v_mfma_f32_16x16x32_bf16 a[116:119], v[220:223], v[116:119], a[116:119]
  s_waitcnt lgkmcnt(5)
  s_add_u32 m0, s31, 0
  s_mov_b32 s42, 65536
  v_cvt_pk_bf16_f32 v128, v128, v129
  v_mfma_f32_16x16x32_bf16 v[164:167], a[236:239], a[172:175], v[56:59]
  v_exp_f32 v176, v176
  v_mfma_f32_16x16x32_bf16 v[164:167], a[232:235], a[168:171], v[164:167]
  v_exp_f32 v177, v177
  v_mfma_f32_16x16x32_bf16 v[164:167], a[228:231], a[164:167], v[164:167]
  v_exp_f32 v160, v160
  v_mfma_f32_16x16x32_bf16 v[164:167], a[224:227], a[160:163], v[164:167]
  buffer_load_dwordx4 v16, s[16:19], s42 offen sc1 nt lds
  v_mfma_f32_16x16x32_bf16 v[132:135], a[236:239], a[140:143], v[48:51]
  v_exp_f32 v161, v161
  v_mfma_f32_16x16x32_bf16 v[132:135], a[232:235], a[136:139], v[132:135]
  v_exp_f32 v144, v144
  v_mfma_f32_16x16x32_bf16 v[132:135], a[228:231], a[132:135], v[132:135]
  v_exp_f32 v145, v145
  v_mfma_f32_16x16x32_bf16 v[132:135], a[224:227], a[128:131], v[132:135]
  v_exp_f32 v164, v164
  v_mfma_f32_16x16x32_bf16 v[212:215], a[252:255], a[156:159], v[52:55]
  buffer_load_dwordx4 v17, s[16:19], s42 offen offset:1024 sc1 nt lds
  v_mfma_f32_16x16x32_bf16 v[212:215], a[248:251], a[152:155], v[212:215]
  v_exp_f32 v165, v165
  v_mfma_f32_16x16x32_bf16 v[212:215], a[244:247], a[148:151], v[212:215]
  s_nop 1
  v_exp_f32 v132, v132
  v_mfma_f32_16x16x32_bf16 v[212:215], a[240:243], a[144:147], v[212:215]
  v_exp_f32 v133, v133
  v_mfma_f32_16x16x32_bf16 v[220:223], a[252:255], a[188:191], v[60:63]
  v_exp_f32 v134, v134
  v_mfma_f32_16x16x32_bf16 v[220:223], a[248:251], a[184:187], v[220:223]
  buffer_load_dwordx4 v18, s[16:19], s42 offen offset:2048 sc1 nt lds
  v_mfma_f32_16x16x32_bf16 v[220:223], a[244:247], a[180:183], v[220:223]
  v_exp_f32 v135, v135
  v_mfma_f32_16x16x32_bf16 v[220:223], a[240:243], a[176:179], v[220:223]
  v_cvt_pk_bf16_f32 v132, v132, v133
  v_cvt_pk_bf16_f32 v129, v130, v131
  v_mfma_f32_16x16x32_bf16 a[96:99], v[180:183], v[116:119], a[96:99]
  v_cvt_pk_bf16_f32 v133, v134, v135
  v_exp_f32 v178, v178
  v_mfma_f32_16x16x32_bf16 a[100:103], v[184:187], v[112:115], 0
  buffer_load_dwordx4 v19, s[16:19], s42 offen offset:3072 sc1 nt lds
  v_mfma_f32_16x16x32_bf16 v[180:183], a[224:227], a[176:179], v[60:63]
  s_add_u32 m0, s31, 16384
  s_mov_b32 s42, 81920
  v_exp_f32 v179, v179
  v_mfma_f32_16x16x32_bf16 v[180:183], a[228:231], a[180:183], v[180:183]
  v_exp_f32 v162, v162
  v_mfma_f32_16x16x32_bf16 v[180:183], a[232:235], a[184:187], v[180:183]
  v_exp_f32 v163, v163
  v_mfma_f32_16x16x32_bf16 v[180:183], a[236:239], a[188:191], v[180:183]
  v_exp_f32 v146, v146
  v_mfma_f32_16x16x32_bf16 v[148:151], a[224:227], a[144:147], v[52:55]
  ds_read_b128 a[224:227], v4 offset:57344
  v_exp_f32 v147, v147
  v_mfma_f32_16x16x32_bf16 v[148:151], a[228:231], a[148:151], v[148:151]
  ds_read_b128 a[228:231], v5 offset:57344
  s_nop 1
  v_exp_f32 v180, v180
  v_mfma_f32_16x16x32_bf16 v[148:151], a[232:235], a[152:155], v[148:151]
  ds_read_b128 a[232:235], v6 offset:57344
  v_exp_f32 v181, v181
  v_mfma_f32_16x16x32_bf16 v[148:151], a[236:239], a[156:159], v[148:151]
  ds_read_b128 a[236:239], v7 offset:57344
  buffer_load_dwordx4 v16, s[16:19], s42 offen sc1 nt lds
  v_mfma_f32_16x16x32_bf16 v[208:211], a[240:243], a[128:131], v[48:51]
  buffer_load_dwordx4 v17, s[16:19], s42 offen offset:1024 sc1 nt lds
  v_mfma_f32_16x16x32_bf16 v[208:211], a[244:247], a[132:135], v[208:211]
  s_nop 2
  v_exp_f32 v148, v148
  v_mfma_f32_16x16x32_bf16 v[208:211], a[248:251], a[136:139], v[208:211]
  v_exp_f32 v149, v149
  v_mfma_f32_16x16x32_bf16 v[208:211], a[252:255], a[140:143], v[208:211]
  v_exp_f32 v182, v182
  v_mfma_f32_16x16x32_bf16 v[216:219], a[240:243], a[160:163], v[56:59]
  ds_read_b128 a[240:243], v4 offset:61440
  v_exp_f32 v183, v183
  v_mfma_f32_16x16x32_bf16 v[216:219], a[244:247], a[164:167], v[216:219]
  ds_read_b128 a[244:247], v5 offset:61440
  buffer_load_dwordx4 v18, s[16:19], s42 offen offset:2048 sc1 nt lds
  v_mfma_f32_16x16x32_bf16 v[216:219], a[248:251], a[168:171], v[216:219]
  ds_read_b128 a[248:251], v6 offset:61440
  v_exp_f32 v208, v208
  v_mfma_f32_16x16x32_bf16 v[216:219], a[252:255], a[172:175], v[216:219]
  ds_read_b128 a[252:255], v7 offset:61440
  v_exp_f32 v209, v209
  v_mfma_f32_16x16x32_bf16 v[184:187], a[192:195], a[176:179], v[60:63]
  v_exp_f32 v210, v210
  v_mfma_f32_16x16x32_bf16 v[184:187], a[196:199], a[180:183], v[184:187]
  buffer_load_dwordx4 v19, s[16:19], s42 offen offset:3072 sc1 nt lds
  v_mfma_f32_16x16x32_bf16 v[184:187], a[200:203], a[184:187], v[184:187]
  s_waitcnt lgkmcnt(4)
  v_exp_f32 v211, v211
  v_mfma_f32_16x16x32_bf16 v[184:187], a[204:207], a[188:191], v[184:187]
  v_exp_f32 v166, v166
  v_mfma_f32_16x16x32_bf16 v[152:155], a[192:195], a[144:147], v[52:55]
  v_exp_f32 v167, v167
  v_mfma_f32_16x16x32_bf16 v[152:155], a[196:199], a[148:151], v[152:155]
  v_exp_f32 v150, v150
  v_mfma_f32_16x16x32_bf16 v[152:155], a[200:203], a[152:155], v[152:155]
  s_nop 1
  v_exp_f32 v184, v184
  v_mfma_f32_16x16x32_bf16 v[152:155], a[204:207], a[156:159], v[152:155]
  v_exp_f32 v185, v185
  v_mfma_f32_16x16x32_bf16 v[224:227], a[208:211], a[128:131], v[48:51]
  v_exp_f32 v151, v151
  v_mfma_f32_16x16x32_bf16 v[224:227], a[212:215], a[132:135], v[224:227]
  v_exp_f32 v186, v186
  v_mfma_f32_16x16x32_bf16 v[224:227], a[216:219], a[136:139], v[224:227]
  s_nop 1
  v_exp_f32 v152, v152
  v_mfma_f32_16x16x32_bf16 v[224:227], a[220:223], a[140:143], v[224:227]
  v_exp_f32 v153, v153
  v_mfma_f32_16x16x32_bf16 v[232:235], a[208:211], a[160:163], v[56:59]
  v_exp_f32 v187, v187
  v_mfma_f32_16x16x32_bf16 v[232:235], a[212:215], a[164:167], v[232:235]
  v_exp_f32 v154, v154
  v_mfma_f32_16x16x32_bf16 v[232:235], a[216:219], a[168:171], v[232:235]
  s_nop 1
  v_exp_f32 v224, v224
  v_mfma_f32_16x16x32_bf16 v[232:235], a[220:223], a[172:175], v[232:235]
  v_exp_f32 v225, v225
  v_mfma_f32_16x16x32_bf16 v[168:171], a[204:207], a[172:175], v[56:59]
  v_exp_f32 v226, v226
  v_mfma_f32_16x16x32_bf16 v[168:171], a[200:203], a[168:171], v[168:171]
  v_exp_f32 v155, v155
  v_mfma_f32_16x16x32_bf16 v[136:139], a[204:207], a[140:143], v[48:51]
  ds_read_b64_tr_b16 a[204:205], v8 offset:24576
  ds_read_b64_tr_b16 a[206:207], v8 offset:28672
  v_mfma_f32_16x16x32_bf16 v[136:139], a[200:203], a[136:139], v[136:139]
  ds_read_b64_tr_b16 a[200:201], v8 offset:16384
  ds_read_b64_tr_b16 a[202:203], v8 offset:20480
  v_mfma_f32_16x16x32_bf16 v[228:231], a[220:223], a[156:159], v[52:55]
  v_cvt_pk_bf16_f32 v130, v192, v193
  v_cvt_pk_bf16_f32 v131, v194, v195
  v_mfma_f32_16x16x32_bf16 v[228:231], a[216:219], a[152:155], v[228:231]
  v_cvt_pk_bf16_f32 v134, v208, v209
  v_cvt_pk_bf16_f32 v135, v210, v211
  v_mfma_f32_16x16x32_bf16 v[236:239], a[220:223], a[188:191], v[60:63]
  ds_read_b64_tr_b16 a[220:221], v9 offset:24576
  ds_read_b64_tr_b16 a[222:223], v9 offset:28672
  v_mfma_f32_16x16x32_bf16 v[236:239], a[216:219], a[184:187], v[236:239]
  ds_read_b64_tr_b16 a[216:217], v9 offset:16384
  ds_read_b64_tr_b16 a[218:219], v9 offset:20480
  v_mfma_f32_16x16x32_bf16 a[100:103], v[188:191], v[116:119], a[100:103]
  v_exp_f32 v196, v196
  v_mfma_f32_16x16x32_bf16 v[188:191], a[224:227], a[176:179], v[60:63]
  v_exp_f32 v197, v197
  v_mfma_f32_16x16x32_bf16 v[188:191], a[228:231], a[180:183], v[188:191]
  v_exp_f32 v198, v198
  v_mfma_f32_16x16x32_bf16 v[188:191], a[232:235], a[184:187], v[188:191]
  v_exp_f32 v199, v199
  v_mfma_f32_16x16x32_bf16 v[188:191], a[236:239], a[188:191], v[188:191]
  v_exp_f32 v200, v200
  v_mfma_f32_16x16x32_bf16 v[156:159], a[224:227], a[144:147], v[52:55]
  v_exp_f32 v201, v201
  v_mfma_f32_16x16x32_bf16 v[156:159], a[228:231], a[148:151], v[156:159]
  v_exp_f32 v202, v202
  v_mfma_f32_16x16x32_bf16 v[156:159], a[232:235], a[152:155], v[156:159]
  s_nop 1
  v_exp_f32 v188, v188
  v_mfma_f32_16x16x32_bf16 v[156:159], a[236:239], a[156:159], v[156:159]
  s_waitcnt lgkmcnt(4)
  v_exp_f32 v189, v189
  v_mfma_f32_16x16x32_bf16 v[240:243], a[240:243], a[128:131], v[48:51]
  v_exp_f32 v203, v203
  v_mfma_f32_16x16x32_bf16 v[240:243], a[244:247], a[132:135], v[240:243]
  v_exp_f32 v204, v204
  v_mfma_f32_16x16x32_bf16 v[240:243], a[248:251], a[136:139], v[240:243]
  s_nop 1
  v_exp_f32 v156, v156
  v_mfma_f32_16x16x32_bf16 v[240:243], a[252:255], a[140:143], v[240:243]
  v_exp_f32 v157, v157
  v_mfma_f32_16x16x32_bf16 v[248:251], a[240:243], a[160:163], v[56:59]
  v_exp_f32 v205, v205
  v_mfma_f32_16x16x32_bf16 v[248:251], a[244:247], a[164:167], v[248:251]
  v_exp_f32 v206, v206
  v_mfma_f32_16x16x32_bf16 v[248:251], a[248:251], a[168:171], v[248:251]
  v_exp_f32 v207, v207
  v_mfma_f32_16x16x32_bf16 v[248:251], a[252:255], a[172:175], v[248:251]
  v_exp_f32 v212, v212
  v_mfma_f32_16x16x32_bf16 v[172:175], a[236:239], a[172:175], v[56:59]
  v_exp_f32 v213, v213
  v_mfma_f32_16x16x32_bf16 v[172:175], a[232:235], a[168:171], v[172:175]
  v_exp_f32 v214, v214
  v_mfma_f32_16x16x32_bf16 v[172:175], a[228:231], a[164:167], v[172:175]
  v_exp_f32 v215, v215
  v_mfma_f32_16x16x32_bf16 v[172:175], a[224:227], a[160:163], v[172:175]
  v_exp_f32 v216, v216
  v_mfma_f32_16x16x32_bf16 v[140:143], a[236:239], a[140:143], v[48:51]
  ds_read_b64_tr_b16 a[236:237], v10 offset:24576
  ds_read_b64_tr_b16 a[238:239], v10 offset:28672
  v_mfma_f32_16x16x32_bf16 v[140:143], a[232:235], a[136:139], v[140:143]
  ds_read_b64_tr_b16 a[232:233], v10 offset:16384
  ds_read_b64_tr_b16 a[234:235], v10 offset:20480
  v_mfma_f32_16x16x32_bf16 v[244:247], a[252:255], a[156:159], v[52:55]
  v_exp_f32 v172, v172
  v_mfma_f32_16x16x32_bf16 v[244:247], a[248:251], a[152:155], v[244:247]
  v_exp_f32 v173, v173
  v_mfma_f32_16x16x32_bf16 v[252:255], a[252:255], a[188:191], v[60:63]
  ds_read_b64_tr_b16 a[252:253], v11 offset:24576
  ds_read_b64_tr_b16 a[254:255], v11 offset:28672
  v_mfma_f32_16x16x32_bf16 v[252:255], a[248:251], a[184:187], v[252:255]
  ds_read_b64_tr_b16 a[248:249], v11 offset:16384
  ds_read_b64_tr_b16 a[250:251], v11 offset:20480
  v_mfma_f32_16x16x32_bf16 a[0:3], a[200:203], v[72:75], a[0:3]
  v_exp_f32 v217, v217
  v_mfma_f32_16x16x32_bf16 a[0:3], a[204:207], v[76:79], a[0:3]
  v_exp_f32 v218, v218
  v_mfma_f32_16x16x32_bf16 a[32:35], a[204:207], v[92:95], a[32:35]
  v_exp_f32 v219, v219
  v_mfma_f32_16x16x32_bf16 a[32:35], a[200:203], v[88:91], a[32:35]
  v_exp_f32 v220, v220
  v_mfma_f32_16x16x32_bf16 a[64:67], a[200:203], v[104:107], a[64:67]
  v_exp_f32 v221, v221
  v_mfma_f32_16x16x32_bf16 a[64:67], a[204:207], v[108:111], a[64:67]
  v_exp_f32 v222, v222
  v_mfma_f32_16x16x32_bf16 a[96:99], a[204:207], v[124:127], a[96:99]
  ds_read_b64_tr_b16 a[204:205], v12 offset:24576
  ds_read_b64_tr_b16 a[206:207], v12 offset:28672
  v_mfma_f32_16x16x32_bf16 a[96:99], a[200:203], v[120:123], a[96:99]
  s_waitcnt lgkmcnt(8)
  ds_read_b64_tr_b16 a[200:201], v12 offset:16384
  ds_read_b64_tr_b16 a[202:203], v12 offset:20480
  v_mfma_f32_16x16x32_bf16 a[100:103], a[216:219], v[120:123], a[100:103]
  v_exp_f32 v223, v223
  v_mfma_f32_16x16x32_bf16 a[100:103], a[220:223], v[124:127], a[100:103]
  v_exp_f32 v227, v227
  v_mfma_f32_16x16x32_bf16 a[68:71], a[220:223], v[108:111], a[68:71]
  v_exp_f32 v232, v232
  v_mfma_f32_16x16x32_bf16 a[68:71], a[216:219], v[104:107], a[68:71]
  v_exp_f32 v233, v233
  v_mfma_f32_16x16x32_bf16 a[36:39], a[216:219], v[88:91], a[36:39]
  v_exp_f32 v234, v234
  v_mfma_f32_16x16x32_bf16 a[36:39], a[220:223], v[92:95], a[36:39]
  v_exp_f32 v235, v235
  v_mfma_f32_16x16x32_bf16 a[4:7], a[220:223], v[76:79], a[4:7]
  ds_read_b64_tr_b16 a[220:221], v13 offset:24576
  ds_read_b64_tr_b16 a[222:223], v13 offset:28672
  v_mfma_f32_16x16x32_bf16 a[4:7], a[216:219], v[72:75], a[4:7]
  ds_read_b64_tr_b16 a[216:217], v13 offset:16384
  ds_read_b64_tr_b16 a[218:219], v13 offset:20480
  v_mfma_f32_16x16x32_bf16 v[136:139], a[196:199], a[132:135], v[136:139]
  v_exp_f32 v190, v190
  v_mfma_f32_16x16x32_bf16 v[136:139], a[192:195], a[128:131], v[136:139]
  v_exp_f32 v191, v191
  v_mfma_f32_16x16x32_bf16 v[168:171], a[196:199], a[164:167], v[168:171]
  v_exp_f32 v174, v174
  v_mfma_f32_16x16x32_bf16 v[168:171], a[192:195], a[160:163], v[168:171]
  v_exp_f32 v175, v175
  v_mfma_f32_16x16x32_bf16 v[228:231], a[212:215], a[148:151], v[228:231]
  s_nop 1
  v_exp_f32 v136, v136
  v_mfma_f32_16x16x32_bf16 v[228:231], a[208:211], a[144:147], v[228:231]
  v_exp_f32 v137, v137
  v_mfma_f32_16x16x32_bf16 v[236:239], a[212:215], a[180:183], v[236:239]
  v_add_f32 v28, v28, v136
  v_exp_f32 v138, v138
  v_mfma_f32_16x16x32_bf16 v[236:239], a[208:211], a[176:179], v[236:239]
  v_add_f32 v28, v28, v137
  v_exp_f32 v139, v139
  v_smfmac_f32_16x16x64_bf16 v[44:47], v[24:27], v[112:119], v23
  v_add_f32 v28, v28, v138
  v_smfmac_f32_16x16x64_bf16 v[44:47], v[24:27], v[120:127], v23
  v_add_f32 v28, v28, v139
  v_mfma_f32_16x16x32_bf16 v[140:143], a[228:231], a[132:135], v[140:143]
  ds_read_b64_tr_b16 a[228:229], v14 offset:8192
  ds_read_b64_tr_b16 a[230:231], v14 offset:12288
  v_mfma_f32_16x16x32_bf16 v[140:143], a[224:227], a[128:131], v[140:143]
  ds_read_b64_tr_b16 a[224:225], v14 offset:0
  ds_read_b64_tr_b16 a[226:227], v14 offset:4096
  v_mfma_f32_16x16x32_bf16 v[244:247], a[244:247], a[148:151], v[244:247]
  v_exp_f32 v168, v168
  v_mfma_f32_16x16x32_bf16 v[244:247], a[240:243], a[144:147], v[244:247]
  v_exp_f32 v169, v169
  v_mfma_f32_16x16x32_bf16 v[252:255], a[244:247], a[180:183], v[252:255]
  ds_read_b64_tr_b16 a[244:245], v15 offset:8192
  ds_read_b64_tr_b16 a[246:247], v15 offset:12288
  v_mfma_f32_16x16x32_bf16 v[252:255], a[240:243], a[176:179], v[252:255]
  s_waitcnt lgkmcnt(6)
  ds_read_b64_tr_b16 a[240:241], v15 offset:0
  ds_read_b64_tr_b16 a[242:243], v15 offset:4096
  v_mfma_f32_16x16x32_bf16 a[8:11], a[232:235], v[72:75], a[8:11]
  v_add_f32 v28, v28, v224
  v_exp_f32 v170, v170
  v_mfma_f32_16x16x32_bf16 a[8:11], a[236:239], v[76:79], a[8:11]
  v_exp_f32 v171, v171
  v_mfma_f32_16x16x32_bf16 a[40:43], a[236:239], v[92:95], a[40:43]
  v_add_f32 v28, v28, v225
  v_exp_f32 v228, v228
  v_mfma_f32_16x16x32_bf16 a[40:43], a[232:235], v[88:91], a[40:43]
  v_exp_f32 v229, v229
  v_mfma_f32_16x16x32_bf16 a[72:75], a[232:235], v[104:107], a[72:75]
  v_exp_f32 v230, v230
  v_mfma_f32_16x16x32_bf16 a[72:75], a[236:239], v[108:111], a[72:75]
  v_exp_f32 v231, v231
  v_mfma_f32_16x16x32_bf16 a[104:107], a[236:239], v[124:127], a[104:107]
  ds_read_b64_tr_b16 a[236:237], v14 offset:24576
  ds_read_b64_tr_b16 a[238:239], v14 offset:28672
  v_mfma_f32_16x16x32_bf16 a[104:107], a[232:235], v[120:123], a[104:107]
  ds_read_b64_tr_b16 a[232:233], v14 offset:16384
  ds_read_b64_tr_b16 a[234:235], v14 offset:20480
  v_mfma_f32_16x16x32_bf16 a[108:111], a[248:251], v[120:123], a[108:111]
  v_exp_f32 v236, v236
  v_mfma_f32_16x16x32_bf16 a[108:111], a[252:255], v[124:127], a[108:111]
  v_exp_f32 v237, v237
  v_mfma_f32_16x16x32_bf16 a[76:79], a[252:255], v[108:111], a[76:79]
  v_exp_f32 v238, v238
  v_mfma_f32_16x16x32_bf16 a[76:79], a[248:251], v[104:107], a[76:79]
  v_exp_f32 v239, v239
  v_mfma_f32_16x16x32_bf16 a[44:47], a[248:251], v[88:91], a[44:47]
  v_exp_f32 v158, v158
  v_mfma_f32_16x16x32_bf16 a[44:47], a[252:255], v[92:95], a[44:47]
  v_exp_f32 v159, v159
  v_mfma_f32_16x16x32_bf16 a[12:15], a[252:255], v[76:79], a[12:15]
  ds_read_b64_tr_b16 a[252:253], v15 offset:24576
  ds_read_b64_tr_b16 a[254:255], v15 offset:28672
  v_mfma_f32_16x16x32_bf16 a[12:15], a[248:251], v[72:75], a[12:15]
  ds_read_b64_tr_b16 a[248:249], v15 offset:16384
  ds_read_b64_tr_b16 a[250:251], v15 offset:20480
  v_mfma_f32_16x16x32_bf16 a[16:19], a[200:203], v[72:75], a[16:19]
  v_cvt_pk_bf16_f32 v176, v176, v177
  v_cvt_pk_bf16_f32 v160, v160, v161
  v_mfma_f32_16x16x32_bf16 a[16:19], a[204:207], v[76:79], a[16:19]
  v_cvt_pk_bf16_f32 v144, v144, v145
  v_cvt_pk_bf16_f32 v180, v180, v181
  v_mfma_f32_16x16x32_bf16 a[48:51], a[204:207], v[92:95], a[48:51]
  v_cvt_pk_bf16_f32 v164, v164, v165
  v_cvt_pk_bf16_f32 v148, v148, v149
  v_mfma_f32_16x16x32_bf16 a[48:51], a[200:203], v[88:91], a[48:51]
  v_cvt_pk_bf16_f32 v184, v184, v185
  v_cvt_pk_bf16_f32 v168, v168, v169
  v_mfma_f32_16x16x32_bf16 a[80:83], a[200:203], v[104:107], a[80:83]
  v_cvt_pk_bf16_f32 v152, v152, v153
  v_cvt_pk_bf16_f32 v136, v136, v137
  v_mfma_f32_16x16x32_bf16 a[80:83], a[204:207], v[108:111], a[80:83]
  v_add_f32 v28, v28, v226
  v_cvt_pk_bf16_f32 v177, v178, v179
  v_mfma_f32_16x16x32_bf16 a[112:115], a[204:207], v[124:127], a[112:115]
  v_cvt_pk_bf16_f32 v161, v162, v163
  v_cvt_pk_bf16_f32 v145, v146, v147
  v_mfma_f32_16x16x32_bf16 a[112:115], a[200:203], v[120:123], a[112:115]
  v_cvt_pk_bf16_f32 v181, v182, v183
  v_cvt_pk_bf16_f32 v165, v166, v167
  v_mfma_f32_16x16x32_bf16 a[116:119], a[216:219], v[120:123], a[116:119]
  v_cvt_pk_bf16_f32 v149, v150, v151
  v_cvt_pk_bf16_f32 v185, v186, v187
  v_mfma_f32_16x16x32_bf16 a[116:119], a[220:223], v[124:127], a[116:119]
  v_cvt_pk_bf16_f32 v169, v170, v171
  v_cvt_pk_bf16_f32 v153, v154, v155
  v_mfma_f32_16x16x32_bf16 a[84:87], a[220:223], v[108:111], a[84:87]
  v_cvt_pk_bf16_f32 v137, v138, v139
  v_cvt_pk_bf16_f32 v188, v188, v189
  v_mfma_f32_16x16x32_bf16 a[84:87], a[216:219], v[104:107], a[84:87]
L_pad2:
  s_cbranch_execz L_back
  v_cvt_pk_bf16_f32 v172, v172, v173
  v_cvt_pk_bf16_f32 v156, v156, v157
  v_mfma_f32_16x16x32_bf16 a[52:55], a[216:219], v[88:91], a[52:55]
  v_cvt_pk_bf16_f32 v146, v196, v197
  v_cvt_pk_bf16_f32 v147, v198, v199
  v_mfma_f32_16x16x32_bf16 a[52:55], a[220:223], v[92:95], a[52:55]
  v_cvt_pk_bf16_f32 v162, v200, v201
  v_cvt_pk_bf16_f32 v163, v202, v203
  v_mfma_f32_16x16x32_bf16 a[20:23], a[220:223], v[76:79], a[20:23]
  v_cvt_pk_bf16_f32 v178, v204, v205
  v_cvt_pk_bf16_f32 v179, v206, v207
  v_mfma_f32_16x16x32_bf16 a[20:23], a[216:219], v[72:75], a[20:23]
  v_cvt_pk_bf16_f32 v150, v212, v213
  v_cvt_pk_bf16_f32 v151, v214, v215
  v_smfmac_f32_16x16x64_bf16 v[32:35], v[24:27], v[128:135], v23
  v_cvt_pk_bf16_f32 v166, v216, v217
  v_cvt_pk_bf16_f32 v167, v218, v219
  v_cvt_pk_bf16_f32 v182, v220, v221
  v_cvt_pk_bf16_f32 v183, v222, v223
  v_cvt_pk_bf16_f32 v138, v224, v225
  v_add_f32 v28, v28, v227
  v_cvt_pk_bf16_f32 v139, v226, v227
  v_cvt_pk_bf16_f32 v154, v228, v229
  v_cvt_pk_bf16_f32 v155, v230, v231
  v_cvt_pk_bf16_f32 v170, v232, v233
  v_cvt_pk_bf16_f32 v171, v234, v235
  v_cvt_pk_bf16_f32 v186, v236, v237
  v_cvt_pk_bf16_f32 v187, v238, v239
  v_cvt_pk_bf16_f32 v189, v190, v191
  v_cvt_pk_bf16_f32 v173, v174, v175
  v_cvt_pk_bf16_f32 v157, v158, v159
  s_waitcnt vmcnt(0) lgkmcnt(0)
.p2align 6
L_loop:
  v_mfma_f32_16x16x32_bf16 a[24:27], a[224:227], v[64:67], a[24:27]
  s_barrier
  v_exp_f32 v140, v140
  v_mfma_f32_16x16x32_bf16 a[24:27], a[228:231], v[68:71], a[24:27]
  ds_read_b128 a[192:195], v4 offset:0
  v_add_f32 v28, v28, v140
  v_mfma_f32_16x16x32_bf16 a[24:27], a[232:235], v[72:75], a[24:27]
  s_add_u32 m0, s32, 0
  v_exp_f32 v141, v141
  v_mfma_f32_16x16x32_bf16 a[24:27], a[236:239], v[76:79], a[24:27]
  buffer_load_dwordx4 v20, s[20:23], s39 offen sc1 nt lds
  v_mfma_f32_16x16x32_bf16 a[56:59], a[236:239], v[92:95], a[56:59]
  v_exp_f32 v142, v142
  v_mfma_f32_16x16x32_bf16 a[56:59], a[232:235], v[88:91], a[56:59]
  ds_read_b128 a[196:199], v5 offset:0
  v_add_f32 v28, v28, v141
  v_mfma_f32_16x16x32_bf16 a[56:59], a[228:231], v[84:87], a[56:59]
  v_exp_f32 v143, v143
  v_mfma_f32_16x16x32_bf16 a[56:59], a[224:227], v[80:83], a[56:59]
  ds_read_b128 a[200:203], v6 offset:0
  v_cvt_pk_bf16_f32 v140, v140, v141
  v_mfma_f32_16x16x32_bf16 a[88:91], a[224:227], v[96:99], a[88:91]
  v_exp_f32 v240, v240
  v_mfma_f32_16x16x32_bf16 a[88:91], a[228:231], v[100:103], a[88:91]
  buffer_load_dwordx4 v21, s[20:23], s39 offen offset:1024 sc1 nt lds
  v_mfma_f32_16x16x32_bf16 a[88:91], a[232:235], v[104:107], a[88:91]
  v_exp_f32 v241, v241
  v_mfma_f32_16x16x32_bf16 a[88:91], a[236:239], v[108:111], a[88:91]
  ds_read_b128 a[204:207], v7 offset:0
  v_add_f32 v28, v28, v142
  v_mfma_f32_16x16x32_bf16 a[120:123], a[236:239], v[124:127], a[120:123]
  v_exp_f32 v242, v242
  v_mfma_f32_16x16x32_bf16 a[120:123], a[232:235], v[120:123], a[120:123]
  ds_read_b128 a[208:211], v4 offset:4096
  v_add_f32 v28, v28, v143
  v_mfma_f32_16x16x32_bf16 a[120:123], a[228:231], v[116:119], a[120:123]
  v_exp_f32 v243, v243
  v_mfma_f32_16x16x32_bf16 a[120:123], a[224:227], v[112:115], a[120:123]
  buffer_load_dwordx4 v20, s[20:23], s39 offen offset:2048 sc1 nt lds
  v_mfma_f32_16x16x32_bf16 a[124:127], a[240:243], v[112:115], a[124:127]
  v_exp_f32 v244, v244
  v_mfma_f32_16x16x32_bf16 a[124:127], a[244:247], v[116:119], a[124:127]
  ds_read_b128 a[212:215], v5 offset:4096
  v_cvt_pk_bf16_f32 v141, v142, v143
  v_mfma_f32_16x16x32_bf16 a[124:127], a[248:251], v[120:123], a[124:127]
  v_exp_f32 v245, v245
  v_mfma_f32_16x16x32_bf16 a[124:127], a[252:255], v[124:127], a[124:127]
  ds_read_b128 a[216:219], v6 offset:4096
  v_add_f32 v28, v28, v240
  v_mfma_f32_16x16x32_bf16 a[92:95], a[252:255], v[108:111], a[92:95]
  v_exp_f32 v246, v246
  v_mfma_f32_16x16x32_bf16 a[92:95], a[248:251], v[104:107], a[92:95]
  buffer_load_dwordx4 v21, s[20:23], s39 offen offset:3072 sc1 nt lds
  v_mfma_f32_16x16x32_bf16 a[92:95], a[244:247], v[100:103], a[92:95]
  s_add_u32 s39, s39, 16384
  v_exp_f32 v247, v247
  v_mfma_f32_16x16x32_bf16 a[92:95], a[240:243], v[96:99], a[92:95]
  ds_read_b128 a[220:223], v7 offset:4096
  v_add_f32 v28, v28, v241
  v_mfma_f32_16x16x32_bf16 a[60:63], a[240:243], v[80:83], a[60:63]
  v_exp_f32 v248, v248
  v_mfma_f32_16x16x32_bf16 a[60:63], a[244:247], v[84:87], a[60:63]
  ds_read_b128 a[224:227], v4 offset:8192
  v_cvt_pk_bf16_f32 v142, v240, v241
  v_mfma_f32_16x16x32_bf16 a[60:63], a[248:251], v[88:91], a[60:63]
  s_add_u32 m0, s32, 16384
  v_exp_f32 v249, v249
  v_mfma_f32_16x16x32_bf16 a[60:63], a[252:255], v[92:95], a[60:63]
  buffer_load_dwordx4 v20, s[20:23], s39 offen sc1 nt lds
  v_mfma_f32_16x16x32_bf16 a[28:31], a[252:255], v[76:79], a[28:31]
  v_exp_f32 v250, v250
  v_mfma_f32_16x16x32_bf16 a[28:31], a[248:251], v[72:75], a[28:31]
  ds_read_b128 a[228:231], v5 offset:8192
  v_add_f32 v28, v28, v242
  v_mfma_f32_16x16x32_bf16 a[28:31], a[244:247], v[68:71], a[28:31]
  v_exp_f32 v251, v251
  v_mfma_f32_16x16x32_bf16 a[28:31], a[240:243], v[64:67], a[28:31]
  s_waitcnt lgkmcnt(1)
  ds_read_b128 a[232:235], v6 offset:8192
  v_add_f32 v28, v28, v243
  v_mfma_f32_16x16x32_bf16 v[112:115], a[192:195], a[176:179], v[60:63]
  v_exp_f32 v252, v252
  v_mfma_f32_16x16x32_bf16 v[112:115], a[196:199], a[180:183], v[112:115]
  buffer_load_dwordx4 v21, s[20:23], s39 offen offset:1024 sc1 nt lds
  v_mfma_f32_16x16x32_bf16 v[112:115], a[200:203], a[184:187], v[112:115]
  v_exp_f32 v253, v253
  v_mfma_f32_16x16x32_bf16 v[112:115], a[204:207], a[188:191], v[112:115]
  ds_read_b128 a[236:239], v7 offset:8192
  v_cvt_pk_bf16_f32 v143, v242, v243
  v_mfma_f32_16x16x32_bf16 v[96:99], a[204:207], a[172:175], v[56:59]
  v_exp_f32 v254, v254
  v_mfma_f32_16x16x32_bf16 v[96:99], a[200:203], a[168:171], v[96:99]
  ds_read_b128 a[240:243], v4 offset:12288
  v_cvt_pk_bf16_f32 v158, v244, v245
  v_mfma_f32_16x16x32_bf16 v[96:99], a[196:199], a[164:167], v[96:99]
  v_exp_f32 v255, v255
  v_mfma_f32_16x16x32_bf16 v[96:99], a[192:195], a[160:163], v[96:99]
  buffer_load_dwordx4 v20, s[20:23], s39 offen offset:2048 sc1 nt lds
  v_mfma_f32_16x16x32_bf16 v[80:83], a[192:195], a[144:147], v[52:55]
  v_exp_f32 v112, v112
  v_mfma_f32_16x16x32_bf16 v[80:83], a[196:199], a[148:151], v[80:83]
  ds_read_b128 a[244:247], v5 offset:12288
  v_cvt_pk_bf16_f32 v159, v246, v247
  v_mfma_f32_16x16x32_bf16 v[80:83], a[200:203], a[152:155], v[80:83]
  v_exp_f32 v113, v113
  v_mfma_f32_16x16x32_bf16 v[80:83], a[204:207], a[156:159], v[80:83]
  ds_read_b128 a[248:251], v6 offset:12288
  v_cvt_pk_bf16_f32 v174, v248, v249
  v_mfma_f32_16x16x32_bf16 v[64:67], a[204:207], a[140:143], v[48:51]
  v_exp_f32 v114, v114
  v_mfma_f32_16x16x32_bf16 v[64:67], a[200:203], a[136:139], v[64:67]
  buffer_load_dwordx4 v21, s[20:23], s39 offen offset:3072 sc1 nt lds
  v_mfma_f32_16x16x32_bf16 v[64:67], a[196:199], a[132:135], v[64:67]
  s_add_u32 s39, s39, 16384
  v_exp_f32 v115, v115
  v_mfma_f32_16x16x32_bf16 v[64:67], a[192:195], a[128:131], v[64:67]
  ds_read_b128 a[252:255], v7 offset:12288
  v_cvt_pk_bf16_f32 v175, v250, v251
  v_mfma_f32_16x16x32_bf16 v[192:195], a[208:211], a[128:131], v[48:51]
  v_exp_f32 v96, v96
  v_mfma_f32_16x16x32_bf16 v[192:195], a[212:215], a[132:135], v[192:195]
  ds_read_b128 a[192:195], v4 offset:16384
  v_cvt_pk_bf16_f32 v190, v252, v253
  v_mfma_f32_16x16x32_bf16 v[192:195], a[216:219], a[136:139], v[192:195]
  s_add_u32 m0, s31, 32768
  v_exp_f32 v97, v97
  v_mfma_f32_16x16x32_bf16 v[192:195], a[220:223], a[140:143], v[192:195]
  buffer_load_dwordx4 v16, s[16:19], s29 offen sc1 nt lds
  v_mfma_f32_16x16x32_bf16 v[196:199], a[220:223], a[156:159], v[52:55]
  v_exp_f32 v98, v98
  v_mfma_f32_16x16x32_bf16 v[196:199], a[216:219], a[152:155], v[196:199]
  ds_read_b128 a[196:199], v5 offset:16384
  v_cvt_pk_bf16_f32 v191, v254, v255
  v_mfma_f32_16x16x32_bf16 v[196:199], a[212:215], a[148:151], v[196:199]
  v_exp_f32 v99, v99
  v_mfma_f32_16x16x32_bf16 v[196:199], a[208:211], a[144:147], v[196:199]
  ds_read_b128 a[200:203], v6 offset:16384
  v_cvt_pk_bf16_f32 v112, v112, v113
  v_mfma_f32_16x16x32_bf16 v[200:203], a[208:211], a[160:163], v[56:59]
  v_exp_f32 v80, v80
  v_mfma_f32_16x16x32_bf16 v[200:203], a[212:215], a[164:167], v[200:203]
  buffer_load_dwordx4 v17, s[16:19], s29 offen offset:1024 sc1 nt lds
  v_mfma_f32_16x16x32_bf16 v[200:203], a[216:219], a[168:171], v[200:203]
  v_exp_f32 v81, v81
  v_mfma_f32_16x16x32_bf16 v[200:203], a[220:223], a[172:175], v[200:203]
  ds_read_b128 a[204:207], v7 offset:16384
  v_cvt_pk_bf16_f32 v113, v114, v115
  v_mfma_f32_16x16x32_bf16 v[204:207], a[220:223], a[188:191], v[60:63]
  v_exp_f32 v82, v82
  v_mfma_f32_16x16x32_bf16 v[204:207], a[216:219], a[184:187], v[204:207]
  v_cvt_pk_bf16_f32 v96, v96, v97
  v_cvt_pk_bf16_f32 v97, v98, v99
  v_mfma_f32_16x16x32_bf16 v[204:207], a[212:215], a[180:183], v[204:207]
  v_exp_f32 v83, v83
  v_mfma_f32_16x16x32_bf16 v[204:207], a[208:211], a[176:179], v[204:207]
  buffer_load_dwordx4 v18, s[16:19], s29 offen offset:2048 sc1 nt lds
  v_smfmac_f32_16x16x64_bf16 v[36:39], v[24:27], v[144:151], v23
  v_cvt_pk_bf16_f32 v80, v80, v81
  v_smfmac_f32_16x16x64_bf16 v[36:39], v[24:27], v[152:159], v23
  v_cvt_pk_bf16_f32 v81, v82, v83
  v_mfma_f32_16x16x32_bf16 v[116:119], a[224:227], a[176:179], v[60:63]
  s_waitcnt lgkmcnt(0)
  v_exp_f32 v64, v64
  v_mfma_f32_16x16x32_bf16 v[116:119], a[228:231], a[180:183], v[116:119]
  ds_read_b128 a[208:211], v4 offset:20480
  v_add_f32 v28, v28, v64
  v_mfma_f32_16x16x32_bf16 v[116:119], a[232:235], a[184:187], v[116:119]
  v_exp_f32 v65, v65
  v_mfma_f32_16x16x32_bf16 v[116:119], a[236:239], a[188:191], v[116:119]
  ds_read_b128 a[212:215], v5 offset:20480
  v_add_f32 v28, v28, v65
  v_mfma_f32_16x16x32_bf16 v[100:103], a[236:239], a[172:175], v[56:59]
  v_exp_f32 v66, v66
  v_mfma_f32_16x16x32_bf16 v[100:103], a[232:235], a[168:171], v[100:103]
  buffer_load_dwordx4 v19, s[16:19], s29 offen offset:3072 sc1 nt lds
  v_mfma_f32_16x16x32_bf16 v[100:103], a[228:231], a[164:167], v[100:103]
  s_add_u32 s29, s29, 16384
  v_exp_f32 v67, v67
  v_mfma_f32_16x16x32_bf16 v[100:103], a[224:227], a[160:163], v[100:103]
  ds_read_b128 a[216:219], v6 offset:20480
  v_cvt_pk_bf16_f32 v64, v64, v65
  v_mfma_f32_16x16x32_bf16 v[84:87], a[224:227], a[144:147], v[52:55]
  v_exp_f32 v192, v192
  v_mfma_f32_16x16x32_bf16 v[84:87], a[228:231], a[148:151], v[84:87]
  ds_read_b128 a[220:223], v7 offset:20480
  v_add_f32 v28, v28, v66
  v_mfma_f32_16x16x32_bf16 v[84:87], a[232:235], a[152:155], v[84:87]
  s_add_u32 m0, s31, 49152
  v_exp_f32 v193, v193
  v_mfma_f32_16x16x32_bf16 v[84:87], a[236:239], a[156:159], v[84:87]
  buffer_load_dwordx4 v16, s[16:19], s29 offen sc1 nt lds
  v_mfma_f32_16x16x32_bf16 v[68:71], a[236:239], a[140:143], v[48:51]
  v_exp_f32 v194, v194
  v_mfma_f32_16x16x32_bf16 v[68:71], a[232:235], a[136:139], v[68:71]
  v_add_f32 v28, v28, v67
  v_cvt_pk_bf16_f32 v65, v66, v67
  v_mfma_f32_16x16x32_bf16 v[68:71], a[228:231], a[132:135], v[68:71]
  v_exp_f32 v195, v195
  v_mfma_f32_16x16x32_bf16 v[68:71], a[224:227], a[128:131], v[68:71]
  v_add_f32 v28, v28, v192
  v_add_f32 v28, v28, v193
  v_smfmac_f32_16x16x64_bf16 v[40:43], v[24:27], v[160:167], v23
  v_cvt_pk_bf16_f32 v66, v192, v193
  v_smfmac_f32_16x16x64_bf16 v[40:43], v[24:27], v[168:175], v23
  v_add_f32 v28, v28, v194
  v_mfma_f32_16x16x32_bf16 v[208:211], a[240:243], a[128:131], v[48:51]
  v_exp_f32 v196, v196
  v_mfma_f32_16x16x32_bf16 v[208:211], a[244:247], a[132:135], v[208:211]
  buffer_load_dwordx4 v17, s[16:19], s29 offen offset:1024 sc1 nt lds
  v_mfma_f32_16x16x32_bf16 v[208:211], a[248:251], a[136:139], v[208:211]
  v_exp_f32 v197, v197
  v_mfma_f32_16x16x32_bf16 v[208:211], a[252:255], a[140:143], v[208:211]
  ds_read_b128 a[224:227], v4 offset:24576
  v_add_f32 v28, v28, v195
  v_mfma_f32_16x16x32_bf16 v[212:215], a[252:255], a[156:159], v[52:55]
  v_exp_f32 v198, v198
  v_mfma_f32_16x16x32_bf16 v[212:215], a[248:251], a[152:155], v[212:215]
  ds_read_b128 a[228:231], v5 offset:24576
  v_cvt_pk_bf16_f32 v67, v194, v195
  v_mfma_f32_16x16x32_bf16 v[212:215], a[244:247], a[148:151], v[212:215]
  v_exp_f32 v199, v199
  v_mfma_f32_16x16x32_bf16 v[212:215], a[240:243], a[144:147], v[212:215]
  buffer_load_dwordx4 v18, s[16:19], s29 offen offset:2048 sc1 nt lds
  v_mfma_f32_16x16x32_bf16 v[216:219], a[240:243], a[160:163], v[56:59]
  v_exp_f32 v200, v200
  v_mfma_f32_16x16x32_bf16 v[216:219], a[244:247], a[164:167], v[216:219]
  ds_read_b128 a[232:235], v6 offset:24576
  v_cvt_pk_bf16_f32 v82, v196, v197
  v_mfma_f32_16x16x32_bf16 v[216:219], a[248:251], a[168:171], v[216:219]
  v_exp_f32 v201, v201
  v_mfma_f32_16x16x32_bf16 v[216:219], a[252:255], a[172:175], v[216:219]
  ds_read_b128 a[236:239], v7 offset:24576
  v_cvt_pk_bf16_f32 v83, v198, v199
  v_mfma_f32_16x16x32_bf16 v[220:223], a[252:255], a[188:191], v[60:63]
  v_exp_f32 v202, v202
  v_mfma_f32_16x16x32_bf16 v[220:223], a[248:251], a[184:187], v[220:223]
  buffer_load_dwordx4 v19, s[16:19], s29 offen offset:3072 sc1 nt lds
  v_mfma_f32_16x16x32_bf16 v[220:223], a[244:247], a[180:183], v[220:223]
  s_add_u32 s29, s29, 16384
  v_exp_f32 v203, v203
  v_mfma_f32_16x16x32_bf16 v[220:223], a[240:243], a[176:179], v[220:223]
  v_cvt_pk_bf16_f32 v98, v200, v201
  v_cvt_pk_bf16_f32 v99, v202, v203
  v_smfmac_f32_16x16x64_bf16 v[44:47], v[24:27], v[176:183], v23
  v_smfmac_f32_16x16x64_bf16 v[44:47], v[24:27], v[184:191], v23
  v_mfma_f32_16x16x32_bf16 v[120:123], a[192:195], a[176:179], v[60:63]
  v_exp_f32 v204, v204
  v_mfma_f32_16x16x32_bf16 v[120:123], a[196:199], a[180:183], v[120:123]
  ds_read_b128 a[240:243], v4 offset:28672
  ds_read_b128 a[244:247], v5 offset:28672
  v_mfma_f32_16x16x32_bf16 v[120:123], a[200:203], a[184:187], v[120:123]
  v_exp_f32 v205, v205
  v_mfma_f32_16x16x32_bf16 v[120:123], a[204:207], a[188:191], v[120:123]
  ds_read_b128 a[248:251], v6 offset:28672
  v_cvt_pk_bf16_f32 v114, v204, v205
  v_mfma_f32_16x16x32_bf16 v[104:107], a[204:207], a[172:175], v[56:59]
  v_exp_f32 v206, v206
  v_mfma_f32_16x16x32_bf16 v[104:107], a[200:203], a[168:171], v[104:107]
  ds_read_b128 a[252:255], v7 offset:28672
  v_mfma_f32_16x16x32_bf16 v[104:107], a[196:199], a[164:167], v[104:107]
  v_exp_f32 v207, v207
  v_mfma_f32_16x16x32_bf16 v[104:107], a[192:195], a[160:163], v[104:107]
  v_cvt_pk_bf16_f32 v115, v206, v207
  v_mfma_f32_16x16x32_bf16 v[88:91], a[192:195], a[144:147], v[52:55]
  v_exp_f32 v116, v116
  v_mfma_f32_16x16x32_bf16 v[88:91], a[196:199], a[148:151], v[88:91]
  v_mfma_f32_16x16x32_bf16 v[88:91], a[200:203], a[152:155], v[88:91]
  v_exp_f32 v117, v117
  v_mfma_f32_16x16x32_bf16 v[88:91], a[204:207], a[156:159], v[88:91]
  v_cvt_pk_bf16_f32 v116, v116, v117
  v_mfma_f32_16x16x32_bf16 v[72:75], a[204:207], a[140:143], v[48:51]
  v_exp_f32 v118, v118
  v_mfma_f32_16x16x32_bf16 v[72:75], a[200:203], a[136:139], v[72:75]
  v_mfma_f32_16x16x32_bf16 v[72:75], a[196:199], a[132:135], v[72:75]
  v_exp_f32 v119, v119
  v_mfma_f32_16x16x32_bf16 v[72:75], a[192:195], a[128:131], v[72:75]
  s_waitcnt lgkmcnt(0)
  v_cvt_pk_bf16_f32 v117, v118, v119
  v_mfma_f32_16x16x32_bf16 v[224:227], a[208:211], a[128:131], v[48:51]
  v_exp_f32 v100, v100
  v_mfma_f32_16x16x32_bf16 v[224:227], a[212:215], a[132:135], v[224:227]
  ds_read_b64_tr_b16 a[192:193], v8 offset:32768
  ds_read_b64_tr_b16 a[194:195], v8 offset:36864
  v_mfma_f32_16x16x32_bf16 v[224:227], a[216:219], a[136:139], v[224:227]
  v_exp_f32 v101, v101
  v_mfma_f32_16x16x32_bf16 v[224:227], a[220:223], a[140:143], v[224:227]
  ds_read_b64_tr_b16 a[196:197], v8 offset:40960
  v_cvt_pk_bf16_f32 v100, v100, v101
  v_mfma_f32_16x16x32_bf16 v[228:231], a[220:223], a[156:159], v[52:55]
  v_exp_f32 v102, v102
  v_mfma_f32_16x16x32_bf16 v[228:231], a[216:219], a[152:155], v[228:231]
  ds_read_b64_tr_b16 a[198:199], v8 offset:45056
  ds_read_b64_tr_b16 a[200:201], v8 offset:49152
  v_mfma_f32_16x16x32_bf16 v[228:231], a[212:215], a[148:151], v[228:231]
  v_exp_f32 v103, v103
  v_mfma_f32_16x16x32_bf16 v[228:231], a[208:211], a[144:147], v[228:231]
  ds_read_b64_tr_b16 a[202:203], v8 offset:53248
  v_cvt_pk_bf16_f32 v101, v102, v103
  v_mfma_f32_16x16x32_bf16 v[232:235], a[208:211], a[160:163], v[56:59]
  v_exp_f32 v84, v84
  v_mfma_f32_16x16x32_bf16 v[232:235], a[212:215], a[164:167], v[232:235]
  ds_read_b64_tr_b16 a[204:205], v8 offset:57344
  ds_read_b64_tr_b16 a[206:207], v8 offset:61440
  v_mfma_f32_16x16x32_bf16 v[232:235], a[216:219], a[168:171], v[232:235]
  v_exp_f32 v85, v85
  v_mfma_f32_16x16x32_bf16 v[232:235], a[220:223], a[172:175], v[232:235]
  v_cvt_pk_bf16_f32 v84, v84, v85
  v_mfma_f32_16x16x32_bf16 v[236:239], a[220:223], a[188:191], v[60:63]
  v_exp_f32 v86, v86
  v_mfma_f32_16x16x32_bf16 v[236:239], a[216:219], a[184:187], v[236:239]
  v_mfma_f32_16x16x32_bf16 v[236:239], a[212:215], a[180:183], v[236:239]
  v_exp_f32 v87, v87
  v_mfma_f32_16x16x32_bf16 v[236:239], a[208:211], a[176:179], v[236:239]
  v_cvt_pk_bf16_f32 v85, v86, v87
  v_mfma_f32_16x16x32_bf16 v[124:127], a[224:227], a[176:179], v[60:63]
  v_exp_f32 v68, v68
  v_mfma_f32_16x16x32_bf16 v[124:127], a[228:231], a[180:183], v[124:127]
  ds_read_b64_tr_b16 a[208:209], v9 offset:32768
  v_add_f32 v28, v28, v68
  v_mfma_f32_16x16x32_bf16 v[124:127], a[232:235], a[184:187], v[124:127]
  v_exp_f32 v69, v69
  v_mfma_f32_16x16x32_bf16 v[124:127], a[236:239], a[188:191], v[124:127]
  ds_read_b64_tr_b16 a[210:211], v9 offset:36864
  v_add_f32 v28, v28, v69
  v_mfma_f32_16x16x32_bf16 v[108:111], a[236:239], a[172:175], v[56:59]
  v_exp_f32 v70, v70
  v_mfma_f32_16x16x32_bf16 v[108:111], a[232:235], a[168:171], v[108:111]
  ds_read_b64_tr_b16 a[212:213], v9 offset:40960
  v_cvt_pk_bf16_f32 v68, v68, v69
  v_mfma_f32_16x16x32_bf16 v[108:111], a[228:231], a[164:167], v[108:111]
  v_exp_f32 v71, v71
  v_mfma_f32_16x16x32_bf16 v[108:111], a[224:227], a[160:163], v[108:111]
  ds_read_b64_tr_b16 a[214:215], v9 offset:45056
  v_add_f32 v28, v28, v70
  v_mfma_f32_16x16x32_bf16 v[92:95], a[224:227], a[144:147], v[52:55]
  v_exp_f32 v208, v208
  v_mfma_f32_16x16x32_bf16 v[92:95], a[228:231], a[148:151], v[92:95]
  ds_read_b64_tr_b16 a[216:217], v9 offset:49152
  v_add_f32 v28, v28, v71
  v_mfma_f32_16x16x32_bf16 v[92:95], a[232:235], a[152:155], v[92:95]
  v_exp_f32 v209, v209
  v_mfma_f32_16x16x32_bf16 v[92:95], a[236:239], a[156:159], v[92:95]
  ds_read_b64_tr_b16 a[218:219], v9 offset:53248
  v_cvt_pk_bf16_f32 v69, v70, v71
  v_mfma_f32_16x16x32_bf16 v[76:79], a[236:239], a[140:143], v[48:51]
  v_exp_f32 v210, v210
  v_mfma_f32_16x16x32_bf16 v[76:79], a[232:235], a[136:139], v[76:79]
  ds_read_b64_tr_b16 a[220:221], v9 offset:57344
  v_add_f32 v28, v28, v208
  v_mfma_f32_16x16x32_bf16 v[76:79], a[228:231], a[132:135], v[76:79]
  v_exp_f32 v211, v211
  v_mfma_f32_16x16x32_bf16 v[76:79], a[224:227], a[128:131], v[76:79]
  ds_read_b64_tr_b16 a[222:223], v9 offset:61440
  v_add_f32 v28, v28, v209
  v_mfma_f32_16x16x32_bf16 v[240:243], a[240:243], a[128:131], v[48:51]
  v_exp_f32 v212, v212
  v_mfma_f32_16x16x32_bf16 v[240:243], a[244:247], a[132:135], v[240:243]
  ds_read_b64_tr_b16 a[224:225], v10 offset:32768
  v_cvt_pk_bf16_f32 v70, v208, v209
  v_mfma_f32_16x16x32_bf16 v[240:243], a[248:251], a[136:139], v[240:243]
  v_exp_f32 v213, v213
  v_mfma_f32_16x16x32_bf16 v[240:243], a[252:255], a[140:143], v[240:243]
  ds_read_b64_tr_b16 a[226:227], v10 offset:36864
  v_add_f32 v28, v28, v210
  v_mfma_f32_16x16x32_bf16 v[244:247], a[252:255], a[156:159], v[52:55]
  v_exp_f32 v214, v214
  v_mfma_f32_16x16x32_bf16 v[244:247], a[248:251], a[152:155], v[244:247]
  ds_read_b64_tr_b16 a[228:229], v10 offset:40960
  v_add_f32 v28, v28, v211
  v_mfma_f32_16x16x32_bf16 v[244:247], a[244:247], a[148:151], v[244:247]
  v_exp_f32 v215, v215
  v_mfma_f32_16x16x32_bf16 v[244:247], a[240:243], a[144:147], v[244:247]
  ds_read_b64_tr_b16 a[230:231], v10 offset:45056
  v_cvt_pk_bf16_f32 v71, v210, v211
  v_mfma_f32_16x16x32_bf16 v[248:251], a[240:243], a[160:163], v[56:59]
  v_exp_f32 v216, v216
  v_mfma_f32_16x16x32_bf16 v[248:251], a[244:247], a[164:167], v[248:251]
  ds_read_b64_tr_b16 a[232:233], v10 offset:49152
  v_cvt_pk_bf16_f32 v86, v212, v213
  v_mfma_f32_16x16x32_bf16 v[248:251], a[248:251], a[168:171], v[248:251]
  v_exp_f32 v217, v217
  v_mfma_f32_16x16x32_bf16 v[248:251], a[252:255], a[172:175], v[248:251]
  ds_read_b64_tr_b16 a[234:235], v10 offset:53248
  v_cvt_pk_bf16_f32 v87, v214, v215
  v_mfma_f32_16x16x32_bf16 v[252:255], a[252:255], a[188:191], v[60:63]
  v_exp_f32 v218, v218
  v_mfma_f32_16x16x32_bf16 v[252:255], a[248:251], a[184:187], v[252:255]
  ds_read_b64_tr_b16 a[236:237], v10 offset:57344
  v_cvt_pk_bf16_f32 v102, v216, v217
  v_mfma_f32_16x16x32_bf16 v[252:255], a[244:247], a[180:183], v[252:255]
  v_exp_f32 v219, v219
  v_mfma_f32_16x16x32_bf16 v[252:255], a[240:243], a[176:179], v[252:255]
  s_waitcnt lgkmcnt(2)
  ds_read_b64_tr_b16 a[238:239], v10 offset:61440
  v_cvt_pk_bf16_f32 v103, v218, v219
  v_mfma_f32_16x16x32_bf16 a[0:3], a[192:195], v[128:131], a[0:3]
  v_exp_f32 v220, v220
  v_mfma_f32_16x16x32_bf16 a[0:3], a[196:199], v[132:135], a[0:3]
  ds_read_b64_tr_b16 a[240:241], v11 offset:32768
  ds_read_b64_tr_b16 a[242:243], v11 offset:36864
  v_mfma_f32_16x16x32_bf16 a[0:3], a[200:203], v[136:139], a[0:3]
  v_exp_f32 v221, v221
  v_mfma_f32_16x16x32_bf16 a[0:3], a[204:207], v[140:143], a[0:3]
  ds_read_b64_tr_b16 a[244:245], v11 offset:40960
  v_cvt_pk_bf16_f32 v118, v220, v221
  v_mfma_f32_16x16x32_bf16 a[32:35], a[204:207], v[156:159], a[32:35]
  v_exp_f32 v222, v222
  v_mfma_f32_16x16x32_bf16 a[32:35], a[200:203], v[152:155], a[32:35]
  ds_read_b64_tr_b16 a[246:247], v11 offset:45056
  ds_read_b64_tr_b16 a[248:249], v11 offset:49152
  v_mfma_f32_16x16x32_bf16 a[32:35], a[196:199], v[148:151], a[32:35]
  v_exp_f32 v223, v223
  v_mfma_f32_16x16x32_bf16 a[32:35], a[192:195], v[144:147], a[32:35]
  ds_read_b64_tr_b16 a[250:251], v11 offset:53248
  v_cvt_pk_bf16_f32 v119, v222, v223
  v_mfma_f32_16x16x32_bf16 a[64:67], a[192:195], v[160:163], a[64:67]
  v_exp_f32 v120, v120
  v_mfma_f32_16x16x32_bf16 a[64:67], a[196:199], v[164:167], a[64:67]
  ds_read_b64_tr_b16 a[252:253], v11 offset:57344
  ds_read_b64_tr_b16 a[254:255], v11 offset:61440
  v_mfma_f32_16x16x32_bf16 a[64:67], a[200:203], v[168:171], a[64:67]
  v_exp_f32 v121, v121
  v_mfma_f32_16x16x32_bf16 a[64:67], a[204:207], v[172:175], a[64:67]
  v_cvt_pk_bf16_f32 v120, v120, v121
  v_mfma_f32_16x16x32_bf16 a[96:99], a[204:207], v[188:191], a[96:99]
  v_exp_f32 v122, v122
  v_mfma_f32_16x16x32_bf16 a[96:99], a[200:203], v[184:187], a[96:99]
  v_mfma_f32_16x16x32_bf16 a[96:99], a[196:199], v[180:183], a[96:99]
  v_exp_f32 v123, v123
  v_mfma_f32_16x16x32_bf16 a[96:99], a[192:195], v[176:179], a[96:99]
  v_cvt_pk_bf16_f32 v121, v122, v123
  v_mfma_f32_16x16x32_bf16 a[100:103], a[208:211], v[176:179], a[100:103]
  v_exp_f32 v104, v104
  v_mfma_f32_16x16x32_bf16 a[100:103], a[212:215], v[180:183], a[100:103]
  ds_read_b64_tr_b16 a[192:193], v12 offset:32768
  ds_read_b64_tr_b16 a[194:195], v12 offset:36864
  v_mfma_f32_16x16x32_bf16 a[100:103], a[216:219], v[184:187], a[100:103]
  v_exp_f32 v105, v105
  v_mfma_f32_16x16x32_bf16 a[100:103], a[220:223], v[188:191], a[100:103]
  ds_read_b64_tr_b16 a[196:197], v12 offset:40960
  v_cvt_pk_bf16_f32 v104, v104, v105
  v_mfma_f32_16x16x32_bf16 a[68:71], a[220:223], v[172:175], a[68:71]
  v_exp_f32 v106, v106
  v_mfma_f32_16x16x32_bf16 a[68:71], a[216:219], v[168:171], a[68:71]
  ds_read_b64_tr_b16 a[198:199], v12 offset:45056
  ds_read_b64_tr_b16 a[200:201], v12 offset:49152
  v_mfma_f32_16x16x32_bf16 a[68:71], a[212:215], v[164:167], a[68:71]
  v_exp_f32 v107, v107
  v_mfma_f32_16x16x32_bf16 a[68:71], a[208:211], v[160:163], a[68:71]
  ds_read_b64_tr_b16 a[202:203], v12 offset:53248
  v_cvt_pk_bf16_f32 v105, v106, v107
  v_mfma_f32_16x16x32_bf16 a[36:39], a[208:211], v[144:147], a[36:39]
  v_exp_f32 v88, v88
  v_mfma_f32_16x16x32_bf16 a[36:39], a[212:215], v[148:151], a[36:39]
  ds_read_b64_tr_b16 a[204:205], v12 offset:57344
  ds_read_b64_tr_b16 a[206:207], v12 offset:61440
  v_mfma_f32_16x16x32_bf16 a[36:39], a[216:219], v[152:155], a[36:39]
  v_exp_f32 v89, v89
  v_mfma_f32_16x16x32_bf16 a[36:39], a[220:223], v[156:159], a[36:39]
  v_cvt_pk_bf16_f32 v88, v88, v89
  v_mfma_f32_16x16x32_bf16 a[4:7], a[220:223], v[140:143], a[4:7]
  v_exp_f32 v90, v90
  v_mfma_f32_16x16x32_bf16 a[4:7], a[216:219], v[136:139], a[4:7]
  v_mfma_f32_16x16x32_bf16 a[4:7], a[212:215], v[132:135], a[4:7]
  v_exp_f32 v91, v91
  v_mfma_f32_16x16x32_bf16 a[4:7], a[208:211], v[128:131], a[4:7]
  v_cvt_pk_bf16_f32 v89, v90, v91
  v_mfma_f32_16x16x32_bf16 a[8:11], a[224:227], v[128:131], a[8:11]
  v_exp_f32 v72, v72
  v_mfma_f32_16x16x32_bf16 a[8:11], a[228:231], v[132:135], a[8:11]
  s_waitcnt lgkmcnt(0)
  ds_read_b64_tr_b16 a[208:209], v13 offset:32768
  v_add_f32 v28, v28, v72
  v_mfma_f32_16x16x32_bf16 a[8:11], a[232:235], v[136:139], a[8:11]
  v_exp_f32 v73, v73
  v_mfma_f32_16x16x32_bf16 a[8:11], a[236:239], v[140:143], a[8:11]
  ds_read_b64_tr_b16 a[210:211], v13 offset:36864
  v_add_f32 v28, v28, v73
  v_mfma_f32_16x16x32_bf16 a[40:43], a[236:239], v[156:159], a[40:43]
  v_exp_f32 v74, v74
  v_mfma_f32_16x16x32_bf16 a[40:43], a[232:235], v[152:155], a[40:43]
  ds_read_b64_tr_b16 a[212:213], v13 offset:40960
  v_cvt_pk_bf16_f32 v72, v72, v73
  v_mfma_f32_16x16x32_bf16 a[40:43], a[228:231], v[148:151], a[40:43]
  v_exp_f32 v75, v75
  v_mfma_f32_16x16x32_bf16 a[40:43], a[224:227], v[144:147], a[40:43]
  ds_read_b64_tr_b16 a[214:215], v13 offset:45056
  v_add_f32 v28, v28, v74
  v_mfma_f32_16x16x32_bf16 a[72:75], a[224:227], v[160:163], a[72:75]
  v_exp_f32 v224, v224
  v_mfma_f32_16x16x32_bf16 a[72:75], a[228:231], v[164:167], a[72:75]
  ds_read_b64_tr_b16 a[216:217], v13 offset:49152
  v_add_f32 v28, v28, v75
  v_mfma_f32_16x16x32_bf16 a[72:75], a[232:235], v[168:171], a[72:75]
  v_exp_f32 v225, v225
  v_mfma_f32_16x16x32_bf16 a[72:75], a[236:239], v[172:175], a[72:75]
  ds_read_b64_tr_b16 a[218:219], v13 offset:53248
  v_cvt_pk_bf16_f32 v73, v74, v75
  v_mfma_f32_16x16x32_bf16 a[104:107], a[236:239], v[188:191], a[104:107]
  v_exp_f32 v226, v226
  v_mfma_f32_16x16x32_bf16 a[104:107], a[232:235], v[184:187], a[104:107]
  ds_read_b64_tr_b16 a[220:221], v13 offset:57344
  v_add_f32 v28, v28, v224
  v_mfma_f32_16x16x32_bf16 a[104:107], a[228:231], v[180:183], a[104:107]
  v_exp_f32 v227, v227
  v_mfma_f32_16x16x32_bf16 a[104:107], a[224:227], v[176:179], a[104:107]
  ds_read_b64_tr_b16 a[222:223], v13 offset:61440
  v_add_f32 v28, v28, v225
  v_mfma_f32_16x16x32_bf16 a[108:111], a[240:243], v[176:179], a[108:111]
  v_exp_f32 v228, v228
  v_mfma_f32_16x16x32_bf16 a[108:111], a[244:247], v[180:183], a[108:111]
  ds_read_b64_tr_b16 a[224:225], v14 offset:32768
  v_cvt_pk_bf16_f32 v74, v224, v225
  v_mfma_f32_16x16x32_bf16 a[108:111], a[248:251], v[184:187], a[108:111]
  v_exp_f32 v229, v229
  v_mfma_f32_16x16x32_bf16 a[108:111], a[252:255], v[188:191], a[108:111]
  ds_read_b64_tr_b16 a[226:227], v14 offset:36864
  v_add_f32 v28, v28, v226
  v_mfma_f32_16x16x32_bf16 a[76:79], a[252:255], v[172:175], a[76:79]
  v_exp_f32 v230, v230
  v_mfma_f32_16x16x32_bf16 a[76:79], a[248:251], v[168:171], a[76:79]
  ds_read_b64_tr_b16 a[228:229], v14 offset:40960
  v_add_f32 v28, v28, v227
  v_mfma_f32_16x16x32_bf16 a[76:79], a[244:247], v[164:167], a[76:79]
  v_exp_f32 v231, v231
  v_mfma_f32_16x16x32_bf16 a[76:79], a[240:243], v[160:163], a[76:79]
  ds_read_b64_tr_b16 a[230:231], v14 offset:45056
  v_cvt_pk_bf16_f32 v75, v226, v227
  v_mfma_f32_16x16x32_bf16 a[44:47], a[240:243], v[144:147], a[44:47]
  v_exp_f32 v232, v232
  v_mfma_f32_16x16x32_bf16 a[44:47], a[244:247], v[148:151], a[44:47]
  ds_read_b64_tr_b16 a[232:233], v14 offset:49152
  v_cvt_pk_bf16_f32 v90, v228, v229
  v_mfma_f32_16x16x32_bf16 a[44:47], a[248:251], v[152:155], a[44:47]
  v_exp_f32 v233, v233
  v_mfma_f32_16x16x32_bf16 a[44:47], a[252:255], v[156:159], a[44:47]
  ds_read_b64_tr_b16 a[234:235], v14 offset:53248
  v_cvt_pk_bf16_f32 v91, v230, v231
  v_mfma_f32_16x16x32_bf16 a[12:15], a[252:255], v[140:143], a[12:15]
  v_exp_f32 v234, v234
  v_mfma_f32_16x16x32_bf16 a[12:15], a[248:251], v[136:139], a[12:15]
  ds_read_b64_tr_b16 a[236:237], v14 offset:57344
  v_cvt_pk_bf16_f32 v106, v232, v233
  v_mfma_f32_16x16x32_bf16 a[12:15], a[244:247], v[132:135], a[12:15]
  v_exp_f32 v235, v235
  v_mfma_f32_16x16x32_bf16 a[12:15], a[240:243], v[128:131], a[12:15]
  ds_read_b64_tr_b16 a[238:239], v14 offset:61440
  v_cvt_pk_bf16_f32 v107, v234, v235
  v_mfma_f32_16x16x32_bf16 a[16:19], a[192:195], v[128:131], a[16:19]
  v_exp_f32 v236, v236
  v_mfma_f32_16x16x32_bf16 a[16:19], a[196:199], v[132:135], a[16:19]
  ds_read_b64_tr_b16 a[240:241], v15 offset:32768
  ds_read_b64_tr_b16 a[242:243], v15 offset:36864
  v_mfma_f32_16x16x32_bf16 a[16:19], a[200:203], v[136:139], a[16:19]
  v_exp_f32 v237, v237
  v_mfma_f32_16x16x32_bf16 a[16:19], a[204:207], v[140:143], a[16:19]
  ds_read_b64_tr_b16 a[244:245], v15 offset:40960
  v_cvt_pk_bf16_f32 v122, v236, v237
  v_mfma_f32_16x16x32_bf16 a[48:51], a[204:207], v[156:159], a[48:51]
L_pad3:
  s_cbranch_execz L_back
  v_exp_f32 v238, v238
  v_mfma_f32_16x16x32_bf16 a[48:51], a[200:203], v[152:155], a[48:51]
  ds_read_b64_tr_b16 a[246:247], v15 offset:45056
  ds_read_b64_tr_b16 a[248:249], v15 offset:49152
  v_mfma_f32_16x16x32_bf16 a[48:51], a[196:199], v[148:151], a[48:51]
  v_exp_f32 v239, v239
  v_mfma_f32_16x16x32_bf16 a[48:51], a[192:195], v[144:147], a[48:51]
  ds_read_b64_tr_b16 a[250:251], v15 offset:53248
  v_cvt_pk_bf16_f32 v123, v238, v239
  v_mfma_f32_16x16x32_bf16 a[80:83], a[192:195], v[160:163], a[80:83]
  v_exp_f32 v124, v124
  v_mfma_f32_16x16x32_bf16 a[80:83], a[196:199], v[164:167], a[80:83]
  ds_read_b64_tr_b16 a[252:253], v15 offset:57344
  ds_read_b64_tr_b16 a[254:255], v15 offset:61440
  v_mfma_f32_16x16x32_bf16 a[80:83], a[200:203], v[168:171], a[80:83]
  v_exp_f32 v125, v125
  v_mfma_f32_16x16x32_bf16 a[80:83], a[204:207], v[172:175], a[80:83]
  v_cvt_pk_bf16_f32 v124, v124, v125
  v_mfma_f32_16x16x32_bf16 a[112:115], a[204:207], v[188:191], a[112:115]
  v_exp_f32 v126, v126
  v_mfma_f32_16x16x32_bf16 a[112:115], a[200:203], v[184:187], a[112:115]
  v_mfma_f32_16x16x32_bf16 a[112:115], a[196:199], v[180:183], a[112:115]
  v_exp_f32 v127, v127
  v_mfma_f32_16x16x32_bf16 a[112:115], a[192:195], v[176:179], a[112:115]
  s_waitcnt lgkmcnt(0)
  v_cvt_pk_bf16_f32 v125, v126, v127
  v_mfma_f32_16x16x32_bf16 a[116:119], a[208:211], v[176:179], a[116:119]
  v_exp_f32 v108, v108
  v_mfma_f32_16x16x32_bf16 a[116:119], a[212:215], v[180:183], a[116:119]
  v_mfma_f32_16x16x32_bf16 a[116:119], a[216:219], v[184:187], a[116:119]
  v_exp_f32 v109, v109
  v_mfma_f32_16x16x32_bf16 a[116:119], a[220:223], v[188:191], a[116:119]
  v_cvt_pk_bf16_f32 v108, v108, v109
  v_mfma_f32_16x16x32_bf16 a[84:87], a[220:223], v[172:175], a[84:87]
  v_exp_f32 v110, v110
  v_mfma_f32_16x16x32_bf16 a[84:87], a[216:219], v[168:171], a[84:87]
  v_mfma_f32_16x16x32_bf16 a[84:87], a[212:215], v[164:167], a[84:87]
  v_exp_f32 v111, v111
  v_mfma_f32_16x16x32_bf16 a[84:87], a[208:211], v[160:163], a[84:87]
  v_cvt_pk_bf16_f32 v109, v110, v111
  v_mfma_f32_16x16x32_bf16 a[52:55], a[208:211], v[144:147], a[52:55]
  v_exp_f32 v92, v92
  v_mfma_f32_16x16x32_bf16 a[52:55], a[212:215], v[148:151], a[52:55]
  v_mfma_f32_16x16x32_bf16 a[52:55], a[216:219], v[152:155], a[52:55]
  v_exp_f32 v93, v93
  v_mfma_f32_16x16x32_bf16 a[52:55], a[220:223], v[156:159], a[52:55]
  v_cvt_pk_bf16_f32 v92, v92, v93
  v_mfma_f32_16x16x32_bf16 a[20:23], a[220:223], v[140:143], a[20:23]
  v_exp_f32 v94, v94
  v_mfma_f32_16x16x32_bf16 a[20:23], a[216:219], v[136:139], a[20:23]
  v_mfma_f32_16x16x32_bf16 a[20:23], a[212:215], v[132:135], a[20:23]
  v_exp_f32 v95, v95
  v_mfma_f32_16x16x32_bf16 a[20:23], a[208:211], v[128:131], a[20:23]
  s_waitcnt vmcnt(0) lgkmcnt(0)
  v_cvt_pk_bf16_f32 v93, v94, v95
  v_mfma_f32_16x16x32_bf16 a[24:27], a[224:227], v[128:131], a[24:27]
  s_barrier
  v_exp_f32 v76, v76
  v_mfma_f32_16x16x32_bf16 a[24:27], a[228:231], v[132:135], a[24:27]
  ds_read_b128 a[192:195], v4 offset:32768
  v_add_f32 v28, v28, v76
  v_mfma_f32_16x16x32_bf16 a[24:27], a[232:235], v[136:139], a[24:27]
  s_add_u32 m0, s32, 32768
  v_exp_f32 v77, v77
  v_mfma_f32_16x16x32_bf16 a[24:27], a[236:239], v[140:143], a[24:27]
  buffer_load_dwordx4 v20, s[20:23], s39 offen sc1 nt lds
  v_mfma_f32_16x16x32_bf16 a[56:59], a[236:239], v[156:159], a[56:59]
  v_exp_f32 v78, v78
  v_mfma_f32_16x16x32_bf16 a[56:59], a[232:235], v[152:155], a[56:59]
  ds_read_b128 a[196:199], v5 offset:32768
  v_add_f32 v28, v28, v77
  v_mfma_f32_16x16x32_bf16 a[56:59], a[228:231], v[148:151], a[56:59]
  v_exp_f32 v79, v79
  v_mfma_f32_16x16x32_bf16 a[56:59], a[224:227], v[144:147], a[56:59]
  ds_read_b128 a[200:203], v6 offset:32768
  v_cvt_pk_bf16_f32 v76, v76, v77
  v_mfma_f32_16x16x32_bf16 a[88:91], a[224:227], v[160:163], a[88:91]
  v_exp_f32 v240, v240
  v_mfma_f32_16x16x32_bf16 a[88:91], a[228:231], v[164:167], a[88:91]
  buffer_load_dwordx4 v21, s[20:23], s39 offen offset:1024 sc1 nt lds
  v_mfma_f32_16x16x32_bf16 a[88:91], a[232:235], v[168:171], a[88:91]
  v_exp_f32 v241, v241
  v_mfma_f32_16x16x32_bf16 a[88:91], a[236:239], v[172:175], a[88:91]
  ds_read_b128 a[204:207], v7 offset:32768
  v_add_f32 v28, v28, v78
  v_mfma_f32_16x16x32_bf16 a[120:123], a[236:239], v[188:191], a[120:123]
  v_exp_f32 v242, v242
  v_mfma_f32_16x16x32_bf16 a[120:123], a[232:235], v[184:187], a[120:123]
  ds_read_b128 a[208:211], v4 offset:36864
  v_add_f32 v28, v28, v79
  v_mfma_f32_16x16x32_bf16 a[120:123], a[228:231], v[180:183], a[120:123]
  v_exp_f32 v243, v243
  v_mfma_f32_16x16x32_bf16 a[120:123], a[224:227], v[176:179], a[120:123]
  buffer_load_dwordx4 v20, s[20:23], s39 offen offset:2048 sc1 nt lds
  v_mfma_f32_16x16x32_bf16 a[124:127], a[240:243], v[176:179], a[124:127]
  v_exp_f32 v244, v244
  v_mfma_f32_16x16x32_bf16 a[124:127], a[244:247], v[180:183], a[124:127]
  ds_read_b128 a[212:215], v5 offset:36864
  v_cvt_pk_bf16_f32 v77, v78, v79
  v_mfma_f32_16x16x32_bf16 a[124:127], a[248:251], v[184:187], a[124:127]
  v_exp_f32 v245, v245
  v_mfma_f32_16x16x32_bf16 a[124:127], a[252:255], v[188:191], a[124:127]
  ds_read_b128 a[216:219], v6 offset:36864
  v_add_f32 v28, v28, v240
  v_mfma_f32_16x16x32_bf16 a[92:95], a[252:255], v[172:175], a[92:95]
  v_exp_f32 v246, v246
  v_mfma_f32_16x16x32_bf16 a[92:95], a[248:251], v[168:171], a[92:95]
  buffer_load_dwordx4 v21, s[20:23], s39 offen offset:3072 sc1 nt lds
  v_mfma_f32_16x16x32_bf16 a[92:95], a[244:247], v[164:167], a[92:95]
  s_add_u32 s39, s39, 16384
  v_exp_f32 v247, v247
  v_mfma_f32_16x16x32_bf16 a[92:95], a[240:243], v[160:163], a[92:95]
  ds_read_b128 a[220:223], v7 offset:36864
  v_add_f32 v28, v28, v241
  v_mfma_f32_16x16x32_bf16 a[60:63], a[240:243], v[144:147], a[60:63]
  v_exp_f32 v248, v248
  v_mfma_f32_16x16x32_bf16 a[60:63], a[244:247], v[148:151], a[60:63]
  ds_read_b128 a[224:227], v4 offset:40960
  v_cvt_pk_bf16_f32 v78, v240, v241
  v_mfma_f32_16x16x32_bf16 a[60:63], a[248:251], v[152:155], a[60:63]
  s_add_u32 m0, s32, 49152
  v_exp_f32 v249, v249
  v_mfma_f32_16x16x32_bf16 a[60:63], a[252:255], v[156:159], a[60:63]
  buffer_load_dwordx4 v20, s[20:23], s39 offen sc1 nt lds
  v_mfma_f32_16x16x32_bf16 a[28:31], a[252:255], v[140:143], a[28:31]
  v_exp_f32 v250, v250
  v_mfma_f32_16x16x32_bf16 a[28:31], a[248:251], v[136:139], a[28:31]
  ds_read_b128 a[228:231], v5 offset:40960
  v_add_f32 v28, v28, v242
  v_mfma_f32_16x16x32_bf16 a[28:31], a[244:247], v[132:135], a[28:31]
  v_exp_f32 v251, v251
  v_mfma_f32_16x16x32_bf16 a[28:31], a[240:243], v[128:131], a[28:31]
  s_waitcnt lgkmcnt(1)
  ds_read_b128 a[232:235], v6 offset:40960
  v_add_f32 v28, v28, v243
  L_mid:
  v_mfma_f32_16x16x32_bf16 v[176:179], a[192:195], a[176:179], v[60:63]
  v_exp_f32 v252, v252
  v_mfma_f32_16x16x32_bf16 v[176:179], a[196:199], a[180:183], v[176:179]
  buffer_load_dwordx4 v21, s[20:23], s39 offen offset:1024 sc1 nt lds
  v_mfma_f32_16x16x32_bf16 v[176:179], a[200:203], a[184:187], v[176:179]
  v_exp_f32 v253, v253
  v_mfma_f32_16x16x32_bf16 v[176:179], a[204:207], a[188:191], v[176:179]
  ds_read_b128 a[236:239], v7 offset:40960
  v_cvt_pk_bf16_f32 v79, v242, v243
  v_mfma_f32_16x16x32_bf16 v[160:163], a[204:207], a[172:175], v[56:59]
  v_exp_f32 v254, v254
  v_mfma_f32_16x16x32_bf16 v[160:163], a[200:203], a[168:171], v[160:163]
  ds_read_b128 a[240:243], v4 offset:45056
  v_cvt_pk_bf16_f32 v94, v244, v245
  v_mfma_f32_16x16x32_bf16 v[160:163], a[196:199], a[164:167], v[160:163]
  v_exp_f32 v255, v255
  v_mfma_f32_16x16x32_bf16 v[160:163], a[192:195], a[160:163], v[160:163]
  buffer_load_dwordx4 v20, s[20:23], s39 offen offset:2048 sc1 nt lds
  v_mfma_f32_16x16x32_bf16 v[144:147], a[192:195], a[144:147], v[52:55]
  v_exp_f32 v176, v176
  v_mfma_f32_16x16x32_bf16 v[144:147], a[196:199], a[148:151], v[144:147]
  ds_read_b128 a[244:247], v5 offset:45056
  v_cvt_pk_bf16_f32 v95, v246, v247
  v_mfma_f32_16x16x32_bf16 v[144:147], a[200:203], a[152:155], v[144:147]
  v_exp_f32 v177, v177
  v_mfma_f32_16x16x32_bf16 v[144:147], a[204:207], a[156:159], v[144:147]
  ds_read_b128 a[248:251], v6 offset:45056
  v_cvt_pk_bf16_f32 v110, v248, v249
  v_mfma_f32_16x16x32_bf16 v[128:131], a[204:207], a[140:143], v[48:51]
  v_exp_f32 v178, v178
  v_mfma_f32_16x16x32_bf16 v[128:131], a[200:203], a[136:139], v[128:131]
  buffer_load_dwordx4 v21, s[20:23], s39 offen offset:3072 sc1 nt lds
  v_mfma_f32_16x16x32_bf16 v[128:131], a[196:199], a[132:135], v[128:131]
  s_add_u32 s39, s39, 16384
  v_exp_f32 v179, v179
  v_mfma_f32_16x16x32_bf16 v[128:131], a[192:195], a[128:131], v[128:131]
  ds_read_b128 a[252:255], v7 offset:45056
  v_cvt_pk_bf16_f32 v111, v250, v251
  v_mfma_f32_16x16x32_bf16 v[192:195], a[208:211], a[128:131], v[48:51]
  v_exp_f32 v160, v160
  v_mfma_f32_16x16x32_bf16 v[192:195], a[212:215], a[132:135], v[192:195]
  ds_read_b128 a[192:195], v4 offset:49152
  v_cvt_pk_bf16_f32 v126, v252, v253
  v_mfma_f32_16x16x32_bf16 v[192:195], a[216:219], a[136:139], v[192:195]
  s_add_u32 m0, s31, 0
  v_exp_f32 v161, v161
  v_mfma_f32_16x16x32_bf16 v[192:195], a[220:223], a[140:143], v[192:195]
  buffer_load_dwordx4 v16, s[16:19], s29 offen sc1 nt lds
  v_mfma_f32_16x16x32_bf16 v[196:199], a[220:223], a[156:159], v[52:55]
  v_exp_f32 v162, v162
  v_mfma_f32_16x16x32_bf16 v[196:199], a[216:219], a[152:155], v[196:199]
  ds_read_b128 a[196:199], v5 offset:49152
  v_cvt_pk_bf16_f32 v127, v254, v255
  v_mfma_f32_16x16x32_bf16 v[196:199], a[212:215], a[148:151], v[196:199]
  v_exp_f32 v163, v163
  v_mfma_f32_16x16x32_bf16 v[196:199], a[208:211], a[144:147], v[196:199]
  ds_read_b128 a[200:203], v6 offset:49152
  v_cvt_pk_bf16_f32 v176, v176, v177
  v_mfma_f32_16x16x32_bf16 v[200:203], a[208:211], a[160:163], v[56:59]
  v_exp_f32 v144, v144
  v_mfma_f32_16x16x32_bf16 v[200:203], a[212:215], a[164:167], v[200:203]
  buffer_load_dwordx4 v17, s[16:19], s29 offen offset:1024 sc1 nt lds
  v_mfma_f32_16x16x32_bf16 v[200:203], a[216:219], a[168:171], v[200:203]
  v_exp_f32 v145, v145
  v_mfma_f32_16x16x32_bf16 v[200:203], a[220:223], a[172:175], v[200:203]
  ds_read_b128 a[204:207], v7 offset:49152
  v_cvt_pk_bf16_f32 v177, v178, v179
  v_mfma_f32_16x16x32_bf16 v[204:207], a[220:223], a[188:191], v[60:63]
  v_exp_f32 v146, v146
  v_mfma_f32_16x16x32_bf16 v[204:207], a[216:219], a[184:187], v[204:207]
  v_cvt_pk_bf16_f32 v160, v160, v161
  v_cvt_pk_bf16_f32 v161, v162, v163
  v_mfma_f32_16x16x32_bf16 v[204:207], a[212:215], a[180:183], v[204:207]
  v_exp_f32 v147, v147
  v_mfma_f32_16x16x32_bf16 v[204:207], a[208:211], a[176:179], v[204:207]
  buffer_load_dwordx4 v18, s[16:19], s29 offen offset:2048 sc1 nt lds
  v_smfmac_f32_16x16x64_bf16 v[36:39], v[24:27], v[80:87], v23
  v_cvt_pk_bf16_f32 v144, v144, v145
  v_smfmac_f32_16x16x64_bf16 v[36:39], v[24:27], v[88:95], v23
  v_cvt_pk_bf16_f32 v145, v146, v147
  v_mfma_f32_16x16x32_bf16 v[180:183], a[224:227], a[176:179], v[60:63]
  s_waitcnt lgkmcnt(0)
  v_exp_f32 v128, v128
  v_mfma_f32_16x16x32_bf16 v[180:183], a[228:231], a[180:183], v[180:183]
  ds_read_b128 a[208:211], v4 offset:53248
  v_add_f32 v28, v28, v128
  v_mfma_f32_16x16x32_bf16 v[180:183], a[232:235], a[184:187], v[180:183]
  v_exp_f32 v129, v129
  v_mfma_f32_16x16x32_bf16 v[180:183], a[236:239], a[188:191], v[180:183]
  ds_read_b128 a[212:215], v5 offset:53248
  v_add_f32 v28, v28, v129
  v_mfma_f32_16x16x32_bf16 v[164:167], a[236:239], a[172:175], v[56:59]
  v_exp_f32 v130, v130
  v_mfma_f32_16x16x32_bf16 v[164:167], a[232:235], a[168:171], v[164:167]
  buffer_load_dwordx4 v19, s[16:19], s29 offen offset:3072 sc1 nt lds
  v_mfma_f32_16x16x32_bf16 v[164:167], a[228:231], a[164:167], v[164:167]
  s_add_u32 s29, s29, 16384
  v_exp_f32 v131, v131
  v_mfma_f32_16x16x32_bf16 v[164:167], a[224:227], a[160:163], v[164:167]
  ds_read_b128 a[216:219], v6 offset:53248
  v_cvt_pk_bf16_f32 v128, v128, v129
  v_mfma_f32_16x16x32_bf16 v[148:151], a[224:227], a[144:147], v[52:55]
  v_exp_f32 v192, v192
  v_mfma_f32_16x16x32_bf16 v[148:151], a[228:231], a[148:151], v[148:151]
  ds_read_b128 a[220:223], v7 offset:53248
  v_add_f32 v28, v28, v130
  v_mfma_f32_16x16x32_bf16 v[148:151], a[232:235], a[152:155], v[148:151]
  s_add_u32 m0, s31, 16384
  v_exp_f32 v193, v193
  v_mfma_f32_16x16x32_bf16 v[148:151], a[236:239], a[156:159], v[148:151]
  buffer_load_dwordx4 v16, s[16:19], s29 offen sc1 nt lds
  v_mfma_f32_16x16x32_bf16 v[132:135], a[236:239], a[140:143], v[48:51]
  v_exp_f32 v194, v194
  v_mfma_f32_16x16x32_bf16 v[132:135], a[232:235], a[136:139], v[132:135]
  v_add_f32 v28, v28, v131
  v_cvt_pk_bf16_f32 v129, v130, v131
  v_mfma_f32_16x16x32_bf16 v[132:135], a[228:231], a[132:135], v[132:135]
  v_exp_f32 v195, v195
  v_mfma_f32_16x16x32_bf16 v[132:135], a[224:227], a[128:131], v[132:135]
  v_add_f32 v28, v28, v192
  v_add_f32 v28, v28, v193
  v_smfmac_f32_16x16x64_bf16 v[40:43], v[24:27], v[96:103], v23
  v_cvt_pk_bf16_f32 v130, v192, v193
  v_smfmac_f32_16x16x64_bf16 v[40:43], v[24:27], v[104:111], v23
  v_add_f32 v28, v28, v194
  v_mfma_f32_16x16x32_bf16 v[208:211], a[240:243], a[128:131], v[48:51]
  v_exp_f32 v196, v196
  v_mfma_f32_16x16x32_bf16 v[208:211], a[244:247], a[132:135], v[208:211]
  buffer_load_dwordx4 v17, s[16:19], s29 offen offset:1024 sc1 nt lds
  v_mfma_f32_16x16x32_bf16 v[208:211], a[248:251], a[136:139], v[208:211]
  v_exp_f32 v197, v197
  v_mfma_f32_16x16x32_bf16 v[208:211], a[252:255], a[140:143], v[208:211]
  ds_read_b128 a[224:227], v4 offset:57344
  v_add_f32 v28, v28, v195
  v_mfma_f32_16x16x32_bf16 v[212:215], a[252:255], a[156:159], v[52:55]
  v_exp_f32 v198, v198
  v_mfma_f32_16x16x32_bf16 v[212:215], a[248:251], a[152:155], v[212:215]
  ds_read_b128 a[228:231], v5 offset:57344
  v_cvt_pk_bf16_f32 v131, v194, v195
  v_mfma_f32_16x16x32_bf16 v[212:215], a[244:247], a[148:151], v[212:215]
  v_exp_f32 v199, v199
  v_mfma_f32_16x16x32_bf16 v[212:215], a[240:243], a[144:147], v[212:215]
  buffer_load_dwordx4 v18, s[16:19], s29 offen offset:2048 sc1 nt lds
  v_mfma_f32_16x16x32_bf16 v[216:219], a[240:243], a[160:163], v[56:59]
  v_exp_f32 v200, v200
  v_mfma_f32_16x16x32_bf16 v[216:219], a[244:247], a[164:167], v[216:219]
  ds_read_b128 a[232:235], v6 offset:57344
  v_cvt_pk_bf16_f32 v146, v196, v197
  v_mfma_f32_16x16x32_bf16 v[216:219], a[248:251], a[168:171], v[216:219]
  v_exp_f32 v201, v201
  v_mfma_f32_16x16x32_bf16 v[216:219], a[252:255], a[172:175], v[216:219]
  ds_read_b128 a[236:239], v7 offset:57344
  v_cvt_pk_bf16_f32 v147, v198, v199
  v_mfma_f32_16x16x32_bf16 v[220:223], a[252:255], a[188:191], v[60:63]
  v_exp_f32 v202, v202
  v_mfma_f32_16x16x32_bf16 v[220:223], a[248:251], a[184:187], v[220:223]
  buffer_load_dwordx4 v19, s[16:19], s29 offen offset:3072 sc1 nt lds
  v_mfma_f32_16x16x32_bf16 v[220:223], a[244:247], a[180:183], v[220:223]
  s_add_u32 s29, s29, 16384
  v_exp_f32 v203, v203
  v_mfma_f32_16x16x32_bf16 v[220:223], a[240:243], a[176:179], v[220:223]
  v_cvt_pk_bf16_f32 v162, v200, v201
  v_cvt_pk_bf16_f32 v163, v202, v203
  v_smfmac_f32_16x16x64_bf16 v[44:47], v[24:27], v[112:119], v23
  v_smfmac_f32_16x16x64_bf16 v[44:47], v[24:27], v[120:127], v23
  v_mfma_f32_16x16x32_bf16 v[184:187], a[192:195], a[176:179], v[60:63]
  v_exp_f32 v204, v204
  v_mfma_f32_16x16x32_bf16 v[184:187], a[196:199], a[180:183], v[184:187]
  ds_read_b128 a[240:243], v4 offset:61440
  ds_read_b128 a[244:247], v5 offset:61440
  v_mfma_f32_16x16x32_bf16 v[184:187], a[200:203], a[184:187], v[184:187]
  v_exp_f32 v205, v205
  v_mfma_f32_16x16x32_bf16 v[184:187], a[204:207], a[188:191], v[184:187]
  ds_read_b128 a[248:251], v6 offset:61440
  v_cvt_pk_bf16_f32 v178, v204, v205
  v_mfma_f32_16x16x32_bf16 v[168:171], a[204:207], a[172:175], v[56:59]
  v_exp_f32 v206, v206
  v_mfma_f32_16x16x32_bf16 v[168:171], a[200:203], a[168:171], v[168:171]
  ds_read_b128 a[252:255], v7 offset:61440
  v_mfma_f32_16x16x32_bf16 v[168:171], a[196:199], a[164:167], v[168:171]
  v_exp_f32 v207, v207
  v_mfma_f32_16x16x32_bf16 v[168:171], a[192:195], a[160:163], v[168:171]
  v_cvt_pk_bf16_f32 v179, v206, v207
  v_mfma_f32_16x16x32_bf16 v[152:155], a[192:195], a[144:147], v[52:55]
  v_exp_f32 v180, v180
  v_mfma_f32_16x16x32_bf16 v[152:155], a[196:199], a[148:151], v[152:155]
  v_mfma_f32_16x16x32_bf16 v[152:155], a[200:203], a[152:155], v[152:155]
  v_exp_f32 v181, v181
  v_mfma_f32_16x16x32_bf16 v[152:155], a[204:207], a[156:159], v[152:155]
  v_cvt_pk_bf16_f32 v180, v180, v181
  v_mfma_f32_16x16x32_bf16 v[136:139], a[204:207], a[140:143], v[48:51]
  v_exp_f32 v182, v182
  v_mfma_f32_16x16x32_bf16 v[136:139], a[200:203], a[136:139], v[136:139]
  v_mfma_f32_16x16x32_bf16 v[136:139], a[196:199], a[132:135], v[136:139]
  v_exp_f32 v183, v183
  v_mfma_f32_16x16x32_bf16 v[136:139], a[192:195], a[128:131], v[136:139]
  s_waitcnt lgkmcnt(0)
  v_cvt_pk_bf16_f32 v181, v182, v183
  v_mfma_f32_16x16x32_bf16 v[224:227], a[208:211], a[128:131], v[48:51]
  v_exp_f32 v164, v164
  v_mfma_f32_16x16x32_bf16 v[224:227], a[212:215], a[132:135], v[224:227]
  ds_read_b64_tr_b16 a[192:193], v8 offset:0
  ds_read_b64_tr_b16 a[194:195], v8 offset:4096
  v_mfma_f32_16x16x32_bf16 v[224:227], a[216:219], a[136:139], v[224:227]
  v_exp_f32 v165, v165
  v_mfma_f32_16x16x32_bf16 v[224:227], a[220:223], a[140:143], v[224:227]
  ds_read_b64_tr_b16 a[196:197], v8 offset:8192
  v_cvt_pk_bf16_f32 v164, v164, v165
  v_mfma_f32_16x16x32_bf16 v[228:231], a[220:223], a[156:159], v[52:55]
  v_exp_f32 v166, v166
  v_mfma_f32_16x16x32_bf16 v[228:231], a[216:219], a[152:155], v[228:231]
  ds_read_b64_tr_b16 a[198:199], v8 offset:12288
  ds_read_b64_tr_b16 a[200:201], v8 offset:16384
  v_mfma_f32_16x16x32_bf16 v[228:231], a[212:215], a[148:151], v[228:231]
  v_exp_f32 v167, v167
  v_mfma_f32_16x16x32_bf16 v[228:231], a[208:211], a[144:147], v[228:231]
  ds_read_b64_tr_b16 a[202:203], v8 offset:20480
  v_cvt_pk_bf16_f32 v165, v166, v167
  v_mfma_f32_16x16x32_bf16 v[232:235], a[208:211], a[160:163], v[56:59]
  v_exp_f32 v148, v148
  v_mfma_f32_16x16x32_bf16 v[232:235], a[212:215], a[164:167], v[232:235]
  ds_read_b64_tr_b16 a[204:205], v8 offset:24576
  ds_read_b64_tr_b16 a[206:207], v8 offset:28672
  v_mfma_f32_16x16x32_bf16 v[232:235], a[216:219], a[168:171], v[232:235]
  v_exp_f32 v149, v149
  v_mfma_f32_16x16x32_bf16 v[232:235], a[220:223], a[172:175], v[232:235]
  v_cvt_pk_bf16_f32 v148, v148, v149
  v_mfma_f32_16x16x32_bf16 v[236:239], a[220:223], a[188:191], v[60:63]
  v_exp_f32 v150, v150
  v_mfma_f32_16x16x32_bf16 v[236:239], a[216:219], a[184:187], v[236:239]
  v_mfma_f32_16x16x32_bf16 v[236:239], a[212:215], a[180:183], v[236:239]
  v_exp_f32 v151, v151
  v_mfma_f32_16x16x32_bf16 v[236:239], a[208:211], a[176:179], v[236:239]
  v_cvt_pk_bf16_f32 v149, v150, v151
  v_mfma_f32_16x16x32_bf16 v[188:191], a[224:227], a[176:179], v[60:63]
  v_exp_f32 v132, v132
  v_mfma_f32_16x16x32_bf16 v[188:191], a[228:231], a[180:183], v[188:191]
  ds_read_b64_tr_b16 a[208:209], v9 offset:0
  v_add_f32 v28, v28, v132
  v_mfma_f32_16x16x32_bf16 v[188:191], a[232:235], a[184:187], v[188:191]
  v_exp_f32 v133, v133
  v_mfma_f32_16x16x32_bf16 v[188:191], a[236:239], a[188:191], v[188:191]
  ds_read_b64_tr_b16 a[210:211], v9 offset:4096
  v_add_f32 v28, v28, v133
  v_mfma_f32_16x16x32_bf16 v[172:175], a[236:239], a[172:175], v[56:59]
  v_exp_f32 v134, v134
  v_mfma_f32_16x16x32_bf16 v[172:175], a[232:235], a[168:171], v[172:175]
  ds_read_b64_tr_b16 a[212:213], v9 offset:8192
  v_cvt_pk_bf16_f32 v132, v132, v133
  v_mfma_f32_16x16x32_bf16 v[172:175], a[228:231], a[164:167], v[172:175]
  v_exp_f32 v135, v135
  v_mfma_f32_16x16x32_bf16 v[172:175], a[224:227], a[160:163], v[172:175]
  ds_read_b64_tr_b16 a[214:215], v9 offset:12288
  v_add_f32 v28, v28, v134
  v_mfma_f32_16x16x32_bf16 v[156:159], a[224:227], a[144:147], v[52:55]
  v_exp_f32 v208, v208
  v_mfma_f32_16x16x32_bf16 v[156:159], a[228:231], a[148:151], v[156:159]
  ds_read_b64_tr_b16 a[216:217], v9 offset:16384
  v_add_f32 v28, v28, v135
  v_mfma_f32_16x16x32_bf16 v[156:159], a[232:235], a[152:155], v[156:159]
  v_exp_f32 v209, v209
  v_mfma_f32_16x16x32_bf16 v[156:159], a[236:239], a[156:159], v[156:159]
  ds_read_b64_tr_b16 a[218:219], v9 offset:20480
  v_cvt_pk_bf16_f32 v133, v134, v135
  v_mfma_f32_16x16x32_bf16 v[140:143], a[236:239], a[140:143], v[48:51]
  v_exp_f32 v210, v210
  v_mfma_f32_16x16x32_bf16 v[140:143], a[232:235], a[136:139], v[140:143]
  ds_read_b64_tr_b16 a[220:221], v9 offset:24576
  v_add_f32 v28, v28, v208
  v_mfma_f32_16x16x32_bf16 v[140:143], a[228:231], a[132:135], v[140:143]
  v_exp_f32 v211, v211
  v_mfma_f32_16x16x32_bf16 v[140:143], a[224:227], a[128:131], v[140:143]
  ds_read_b64_tr_b16 a[222:223], v9 offset:28672
  v_add_f32 v28, v28, v209
  v_mfma_f32_16x16x32_bf16 v[240:243], a[240:243], a[128:131], v[48:51]
  v_exp_f32 v212, v212
  v_mfma_f32_16x16x32_bf16 v[240:243], a[244:247], a[132:135], v[240:243]
  ds_read_b64_tr_b16 a[224:225], v10 offset:0
  v_cvt_pk_bf16_f32 v134, v208, v209
  v_mfma_f32_16x16x32_bf16 v[240:243], a[248:251], a[136:139], v[240:243]
  v_exp_f32 v213, v213
  v_mfma_f32_16x16x32_bf16 v[240:243], a[252:255], a[140:143], v[240:243]
  ds_read_b64_tr_b16 a[226:227], v10 offset:4096
  v_add_f32 v28, v28, v210
  v_mfma_f32_16x16x32_bf16 v[244:247], a[252:255], a[156:159], v[52:55]
  v_exp_f32 v214, v214
  v_mfma_f32_16x16x32_bf16 v[244:247], a[248:251], a[152:155], v[244:247]
  ds_read_b64_tr_b16 a[228:229], v10 offset:8192
  v_add_f32 v28, v28, v211
  v_mfma_f32_16x16x32_bf16 v[244:247], a[244:247], a[148:151], v[244:247]
  v_exp_f32 v215, v215
  v_mfma_f32_16x16x32_bf16 v[244:247], a[240:243], a[144:147], v[244:247]
  ds_read_b64_tr_b16 a[230:231], v10 offset:12288
  v_cvt_pk_bf16_f32 v135, v210, v211
  v_mfma_f32_16x16x32_bf16 v[248:251], a[240:243], a[160:163], v[56:59]
  v_exp_f32 v216, v216
  v_mfma_f32_16x16x32_bf16 v[248:251], a[244:247], a[164:167], v[248:251]
  ds_read_b64_tr_b16 a[232:233], v10 offset:16384
  v_cvt_pk_bf16_f32 v150, v212, v213
  v_mfma_f32_16x16x32_bf16 v[248:251], a[248:251], a[168:171], v[248:251]
  v_exp_f32 v217, v217
  v_mfma_f32_16x16x32_bf16 v[248:251], a[252:255], a[172:175], v[248:251]
  ds_read_b64_tr_b16 a[234:235], v10 offset:20480
  v_cvt_pk_bf16_f32 v151, v214, v215
  v_mfma_f32_16x16x32_bf16 v[252:255], a[252:255], a[188:191], v[60:63]
  v_exp_f32 v218, v218
  v_mfma_f32_16x16x32_bf16 v[252:255], a[248:251], a[184:187], v[252:255]
  ds_read_b64_tr_b16 a[236:237], v10 offset:24576
  v_cvt_pk_bf16_f32 v166, v216, v217
  v_mfma_f32_16x16x32_bf16 v[252:255], a[244:247], a[180:183], v[252:255]
  v_exp_f32 v219, v219
  v_mfma_f32_16x16x32_bf16 v[252:255], a[240:243], a[176:179], v[252:255]
  s_waitcnt lgkmcnt(2)
  ds_read_b64_tr_b16 a[238:239], v10 offset:28672
  v_cvt_pk_bf16_f32 v167, v218, v219
  v_mfma_f32_16x16x32_bf16 a[0:3], a[192:195], v[64:67], a[0:3]
  v_exp_f32 v220, v220
  v_mfma_f32_16x16x32_bf16 a[0:3], a[196:199], v[68:71], a[0:3]
  ds_read_b64_tr_b16 a[240:241], v11 offset:0
  ds_read_b64_tr_b16 a[242:243], v11 offset:4096
  v_mfma_f32_16x16x32_bf16 a[0:3], a[200:203], v[72:75], a[0:3]
  v_exp_f32 v221, v221
  v_mfma_f32_16x16x32_bf16 a[0:3], a[204:207], v[76:79], a[0:3]
  ds_read_b64_tr_b16 a[244:245], v11 offset:8192
  v_cvt_pk_bf16_f32 v182, v220, v221
  v_mfma_f32_16x16x32_bf16 a[32:35], a[204:207], v[92:95], a[32:35]
  v_exp_f32 v222, v222
  v_mfma_f32_16x16x32_bf16 a[32:35], a[200:203], v[88:91], a[32:35]
  ds_read_b64_tr_b16 a[246:247], v11 offset:12288
  ds_read_b64_tr_b16 a[248:249], v11 offset:16384
  v_mfma_f32_16x16x32_bf16 a[32:35], a[196:199], v[84:87], a[32:35]
  v_exp_f32 v223, v223
  v_mfma_f32_16x16x32_bf16 a[32:35], a[192:195], v[80:83], a[32:35]
  ds_read_b64_tr_b16 a[250:251], v11 offset:20480
  v_cvt_pk_bf16_f32 v183, v222, v223
  v_mfma_f32_16x16x32_bf16 a[64:67], a[192:195], v[96:99], a[64:67]
  v_exp_f32 v184, v184
  v_mfma_f32_16x16x32_bf16 a[64:67], a[196:199], v[100:103], a[64:67]
  ds_read_b64_tr_b16 a[252:253], v11 offset:24576
  ds_read_b64_tr_b16 a[254:255], v11 offset:28672
  v_mfma_f32_16x16x32_bf16 a[64:67], a[200:203], v[104:107], a[64:67]
  v_exp_f32 v185, v185
  v_mfma_f32_16x16x32_bf16 a[64:67], a[204:207], v[108:111], a[64:67]
  v_cvt_pk_bf16_f32 v184, v184, v185
  v_mfma_f32_16x16x32_bf16 a[96:99], a[204:207], v[124:127], a[96:99]
  v_exp_f32 v186, v186
  v_mfma_f32_16x16x32_bf16 a[96:99], a[200:203], v[120:123], a[96:99]
  v_mfma_f32_16x16x32_bf16 a[96:99], a[196:199], v[116:119], a[96:99]
  v_exp_f32 v187, v187
  v_mfma_f32_16x16x32_bf16 a[96:99], a[192:195], v[112:115], a[96:99]
  v_cvt_pk_bf16_f32 v185, v186, v187
  v_mfma_f32_16x16x32_bf16 a[100:103], a[208:211], v[112:115], a[100:103]
  v_exp_f32 v168, v168
  v_mfma_f32_16x16x32_bf16 a[100:103], a[212:215], v[116:119], a[100:103]
  ds_read_b64_tr_b16 a[192:193], v12 offset:0
  ds_read_b64_tr_b16 a[194:195], v12 offset:4096
  v_mfma_f32_16x16x32_bf16 a[100:103], a[216:219], v[120:123], a[100:103]
  v_exp_f32 v169, v169
  v_mfma_f32_16x16x32_bf16 a[100:103], a[220:223], v[124:127], a[100:103]
  ds_read_b64_tr_b16 a[196:197], v12 offset:8192
  v_cvt_pk_bf16_f32 v168, v168, v169
  v_mfma_f32_16x16x32_bf16 a[68:71], a[220:223], v[108:111], a[68:71]
  v_exp_f32 v170, v170
  v_mfma_f32_16x16x32_bf16 a[68:71], a[216:219], v[104:107], a[68:71]
  ds_read_b64_tr_b16 a[198:199], v12 offset:12288
  ds_read_b64_tr_b16 a[200:201], v12 offset:16384
  v_mfma_f32_16x16x32_bf16 a[68:71], a[212:215], v[100:103], a[68:71]
  v_exp_f32 v171, v171
  v_mfma_f32_16x16x32_bf16 a[68:71], a[208:211], v[96:99], a[68:71]
  ds_read_b64_tr_b16 a[202:203], v12 offset:20480
  v_cvt_pk_bf16_f32 v169, v170, v171
  v_mfma_f32_16x16x32_bf16 a[36:39], a[208:211], v[80:83], a[36:39]
  v_exp_f32 v152, v152
  v_mfma_f32_16x16x32_bf16 a[36:39], a[212:215], v[84:87], a[36:39]
  ds_read_b64_tr_b16 a[204:205], v12 offset:24576
  ds_read_b64_tr_b16 a[206:207], v12 offset:28672
  v_mfma_f32_16x16x32_bf16 a[36:39], a[216:219], v[88:91], a[36:39]
  v_exp_f32 v153, v153
  v_mfma_f32_16x16x32_bf16 a[36:39], a[220:223], v[92:95], a[36:39]
  v_cvt_pk_bf16_f32 v152, v152, v153
  v_mfma_f32_16x16x32_bf16 a[4:7], a[220:223], v[76:79], a[4:7]
  v_exp_f32 v154, v154
  v_mfma_f32_16x16x32_bf16 a[4:7], a[216:219], v[72:75], a[4:7]
  v_mfma_f32_16x16x32_bf16 a[4:7], a[212:215], v[68:71], a[4:7]
  v_exp_f32 v155, v155
  v_mfma_f32_16x16x32_bf16 a[4:7], a[208:211], v[64:67], a[4:7]
  v_cvt_pk_bf16_f32 v153, v154, v155
  v_mfma_f32_16x16x32_bf16 a[8:11], a[224:227], v[64:67], a[8:11]
  v_exp_f32 v136, v136
  v_mfma_f32_16x16x32_bf16 a[8:11], a[228:231], v[68:71], a[8:11]
  s_waitcnt lgkmcnt(0)
  ds_read_b64_tr_b16 a[208:209], v13 offset:0
  v_add_f32 v28, v28, v136
  v_mfma_f32_16x16x32_bf16 a[8:11], a[232:235], v[72:75], a[8:11]
  v_exp_f32 v137, v137
  v_mfma_f32_16x16x32_bf16 a[8:11], a[236:239], v[76:79], a[8:11]
  ds_read_b64_tr_b16 a[210:211], v13 offset:4096
  v_add_f32 v28, v28, v137
  v_mfma_f32_16x16x32_bf16 a[40:43], a[236:239], v[92:95], a[40:43]
  v_exp_f32 v138, v138
  v_mfma_f32_16x16x32_bf16 a[40:43], a[232:235], v[88:91], a[40:43]
  ds_read_b64_tr_b16 a[212:213], v13 offset:8192
  v_cvt_pk_bf16_f32 v136, v136, v137
  v_mfma_f32_16x16x32_bf16 a[40:43], a[228:231], v[84:87], a[40:43]
  v_exp_f32 v139, v139
  v_mfma_f32_16x16x32_bf16 a[40:43], a[224:227], v[80:83], a[40:43]
  ds_read_b64_tr_b16 a[214:215], v13 offset:12288
  v_add_f32 v28, v28, v138
  v_mfma_f32_16x16x32_bf16 a[72:75], a[224:227], v[96:99], a[72:75]
  v_exp_f32 v224, v224
  v_mfma_f32_16x16x32_bf16 a[72:75], a[228:231], v[100:103], a[72:75]
  ds_read_b64_tr_b16 a[216:217], v13 offset:16384
  v_add_f32 v28, v28, v139
  v_mfma_f32_16x16x32_bf16 a[72:75], a[232:235], v[104:107], a[72:75]
  v_exp_f32 v225, v225
  v_mfma_f32_16x16x32_bf16 a[72:75], a[236:239], v[108:111], a[72:75]
  ds_read_b64_tr_b16 a[218:219], v13 offset:20480
  v_cvt_pk_bf16_f32 v137, v138, v139
  v_mfma_f32_16x16x32_bf16 a[104:107], a[236:239], v[124:127], a[104:107]
  v_exp_f32 v226, v226
  v_mfma_f32_16x16x32_bf16 a[104:107], a[232:235], v[120:123], a[104:107]
  ds_read_b64_tr_b16 a[220:221], v13 offset:24576
  v_add_f32 v28, v28, v224
  v_mfma_f32_16x16x32_bf16 a[104:107], a[228:231], v[116:119], a[104:107]
  v_exp_f32 v227, v227
  v_mfma_f32_16x16x32_bf16 a[104:107], a[224:227], v[112:115], a[104:107]
  ds_read_b64_tr_b16 a[222:223], v13 offset:28672
  v_add_f32 v28, v28, v225
  v_mfma_f32_16x16x32_bf16 a[108:111], a[240:243], v[112:115], a[108:111]
  v_exp_f32 v228, v228
  v_mfma_f32_16x16x32_bf16 a[108:111], a[244:247], v[116:119], a[108:111]
  ds_read_b64_tr_b16 a[224:225], v14 offset:0
  v_cvt_pk_bf16_f32 v138, v224, v225
  v_mfma_f32_16x16x32_bf16 a[108:111], a[248:251], v[120:123], a[108:111]
  v_exp_f32 v229, v229
  v_mfma_f32_16x16x32_bf16 a[108:111], a[252:255], v[124:127], a[108:111]
  ds_read_b64_tr_b16 a[226:227], v14 offset:4096
  v_add_f32 v28, v28, v226
  v_mfma_f32_16x16x32_bf16 a[76:79], a[252:255], v[108:111], a[76:79]
  v_exp_f32 v230, v230
  v_mfma_f32_16x16x32_bf16 a[76:79], a[248:251], v[104:107], a[76:79]
  ds_read_b64_tr_b16 a[228:229], v14 offset:8192
  v_add_f32 v28, v28, v227
  v_mfma_f32_16x16x32_bf16 a[76:79], a[244:247], v[100:103], a[76:79]
  v_exp_f32 v231, v231
  v_mfma_f32_16x16x32_bf16 a[76:79], a[240:243], v[96:99], a[76:79]
  ds_read_b64_tr_b16 a[230:231], v14 offset:12288
  v_cvt_pk_bf16_f32 v139, v226, v227
  v_mfma_f32_16x16x32_bf16 a[44:47], a[240:243], v[80:83], a[44:47]
  v_exp_f32 v232, v232
  v_mfma_f32_16x16x32_bf16 a[44:47], a[244:247], v[84:87], a[44:47]
  ds_read_b64_tr_b16 a[232:233], v14 offset:16384
  v_cvt_pk_bf16_f32 v154, v228, v229
  v_mfma_f32_16x16x32_bf16 a[44:47], a[248:251], v[88:91], a[44:47]
  v_exp_f32 v233, v233
  v_mfma_f32_16x16x32_bf16 a[44:47], a[252:255], v[92:95], a[44:47]
  ds_read_b64_tr_b16 a[234:235], v14 offset:20480
  v_cvt_pk_bf16_f32 v155, v230, v231
  v_mfma_f32_16x16x32_bf16 a[12:15], a[252:255], v[76:79], a[12:15]
L_pad4:
  s_cbranch_execz L_back
  v_exp_f32 v234, v234
  v_mfma_f32_16x16x32_bf16 a[12:15], a[248:251], v[72:75], a[12:15]
  ds_read_b64_tr_b16 a[236:237], v14 offset:24576
  v_cvt_pk_bf16_f32 v170, v232, v233
  v_mfma_f32_16x16x32_bf16 a[12:15], a[244:247], v[68:71], a[12:15]
  v_exp_f32 v235, v235
  v_mfma_f32_16x16x32_bf16 a[12:15], a[240:243], v[64:67], a[12:15]
  ds_read_b64_tr_b16 a[238:239], v14 offset:28672
  v_cvt_pk_bf16_f32 v171, v234, v235
  v_mfma_f32_16x16x32_bf16 a[16:19], a[192:195], v[64:67], a[16:19]
  v_exp_f32 v236, v236
  v_mfma_f32_16x16x32_bf16 a[16:19], a[196:199], v[68:71], a[16:19]
  ds_read_b64_tr_b16 a[240:241], v15 offset:0
  ds_read_b64_tr_b16 a[242:243], v15 offset:4096
  v_mfma_f32_16x16x32_bf16 a[16:19], a[200:203], v[72:75], a[16:19]
  v_exp_f32 v237, v237
  v_mfma_f32_16x16x32_bf16 a[16:19], a[204:207], v[76:79], a[16:19]
  ds_read_b64_tr_b16 a[244:245], v15 offset:8192
  v_cvt_pk_bf16_f32 v186, v236, v237
  v_mfma_f32_16x16x32_bf16 a[48:51], a[204:207], v[92:95], a[48:51]
  v_exp_f32 v238, v238
  v_mfma_f32_16x16x32_bf16 a[48:51], a[200:203], v[88:91], a[48:51]
  ds_read_b64_tr_b16 a[246:247], v15 offset:12288
  ds_read_b64_tr_b16 a[248:249], v15 offset:16384
  v_mfma_f32_16x16x32_bf16 a[48:51], a[196:199], v[84:87], a[48:51]
  v_exp_f32 v239, v239
  v_mfma_f32_16x16x32_bf16 a[48:51], a[192:195], v[80:83], a[48:51]
  ds_read_b64_tr_b16 a[250:251], v15 offset:20480
  v_cvt_pk_bf16_f32 v187, v238, v239
  v_mfma_f32_16x16x32_bf16 a[80:83], a[192:195], v[96:99], a[80:83]
  v_exp_f32 v188, v188
  v_mfma_f32_16x16x32_bf16 a[80:83], a[196:199], v[100:103], a[80:83]
  ds_read_b64_tr_b16 a[252:253], v15 offset:24576
  ds_read_b64_tr_b16 a[254:255], v15 offset:28672
  v_mfma_f32_16x16x32_bf16 a[80:83], a[200:203], v[104:107], a[80:83]
  v_exp_f32 v189, v189
  v_mfma_f32_16x16x32_bf16 a[80:83], a[204:207], v[108:111], a[80:83]
  v_cvt_pk_bf16_f32 v188, v188, v189
  v_mfma_f32_16x16x32_bf16 a[112:115], a[204:207], v[124:127], a[112:115]
  v_exp_f32 v190, v190
  v_mfma_f32_16x16x32_bf16 a[112:115], a[200:203], v[120:123], a[112:115]
  v_mfma_f32_16x16x32_bf16 a[112:115], a[196:199], v[116:119], a[112:115]
  v_exp_f32 v191, v191
  v_mfma_f32_16x16x32_bf16 a[112:115], a[192:195], v[112:115], a[112:115]
  s_waitcnt lgkmcnt(0)
  v_cvt_pk_bf16_f32 v189, v190, v191
  v_mfma_f32_16x16x32_bf16 a[116:119], a[208:211], v[112:115], a[116:119]
  v_exp_f32 v172, v172
  v_mfma_f32_16x16x32_bf16 a[116:119], a[212:215], v[116:119], a[116:119]
  v_mfma_f32_16x16x32_bf16 a[116:119], a[216:219], v[120:123], a[116:119]
  v_exp_f32 v173, v173
  v_mfma_f32_16x16x32_bf16 a[116:119], a[220:223], v[124:127], a[116:119]
  v_cvt_pk_bf16_f32 v172, v172, v173
  v_mfma_f32_16x16x32_bf16 a[84:87], a[220:223], v[108:111], a[84:87]
  v_exp_f32 v174, v174
  v_mfma_f32_16x16x32_bf16 a[84:87], a[216:219], v[104:107], a[84:87]
  v_mfma_f32_16x16x32_bf16 a[84:87], a[212:215], v[100:103], a[84:87]
  v_exp_f32 v175, v175
  v_mfma_f32_16x16x32_bf16 a[84:87], a[208:211], v[96:99], a[84:87]
  v_cvt_pk_bf16_f32 v173, v174, v175
  v_mfma_f32_16x16x32_bf16 a[52:55], a[208:211], v[80:83], a[52:55]
  v_exp_f32 v156, v156
  v_mfma_f32_16x16x32_bf16 a[52:55], a[212:215], v[84:87], a[52:55]
  v_mfma_f32_16x16x32_bf16 a[52:55], a[216:219], v[88:91], a[52:55]
  v_exp_f32 v157, v157
  v_mfma_f32_16x16x32_bf16 a[52:55], a[220:223], v[92:95], a[52:55]
  v_cvt_pk_bf16_f32 v156, v156, v157
  v_mfma_f32_16x16x32_bf16 a[20:23], a[220:223], v[76:79], a[20:23]
  v_exp_f32 v158, v158
  v_mfma_f32_16x16x32_bf16 a[20:23], a[216:219], v[72:75], a[20:23]
  s_sub_u32 s30, s30, 1
  v_mfma_f32_16x16x32_bf16 a[20:23], a[212:215], v[68:71], a[20:23]
  s_cmp_lg_u32 s30, 0
  v_exp_f32 v159, v159
  v_mfma_f32_16x16x32_bf16 a[20:23], a[208:211], v[64:67], a[20:23]
  s_waitcnt vmcnt(0) lgkmcnt(0)
  v_cvt_pk_bf16_f32 v157, v158, v159
  s_cbranch_scc1 L_loop
  L_tail:
  v_mfma_f32_16x16x32_bf16 a[56:59], a[236:239], v[92:95], a[56:59]
  s_barrier
  ds_read_b64_tr_b16 a[128:129], v8 offset:32768
  ds_read_b64_tr_b16 a[130:131], v8 offset:36864
  v_mfma_f32_16x16x32_bf16 a[56:59], a[232:235], v[88:91], a[56:59]
  ds_read_b64_tr_b16 a[156:157], v9 offset:57344
  ds_read_b64_tr_b16 a[158:159], v9 offset:61440
  v_mfma_f32_16x16x32_bf16 a[56:59], a[228:231], v[84:87], a[56:59]
  ds_read_b64_tr_b16 a[160:161], v10 offset:32768
  ds_read_b64_tr_b16 a[162:163], v10 offset:36864
  v_mfma_f32_16x16x32_bf16 a[56:59], a[224:227], v[80:83], a[56:59]
  ds_read_b64_tr_b16 a[132:133], v8 offset:40960
  ds_read_b64_tr_b16 a[134:135], v8 offset:45056
  v_mfma_f32_16x16x32_bf16 a[120:123], a[236:239], v[124:127], a[120:123]
  ds_read_b64_tr_b16 a[188:189], v11 offset:57344
  ds_read_b64_tr_b16 a[190:191], v11 offset:61440
  v_mfma_f32_16x16x32_bf16 a[120:123], a[232:235], v[120:123], a[120:123]
  ds_read_b64_tr_b16 a[152:153], v9 offset:49152
  ds_read_b64_tr_b16 a[154:155], v9 offset:53248
  v_mfma_f32_16x16x32_bf16 a[120:123], a[228:231], v[116:119], a[120:123]
  ds_read_b64_tr_b16 a[164:165], v10 offset:40960
  ds_read_b64_tr_b16 a[166:167], v10 offset:45056
  v_mfma_f32_16x16x32_bf16 a[120:123], a[224:227], v[112:115], a[120:123]
  ds_read_b64_tr_b16 a[136:137], v8 offset:49152
  ds_read_b64_tr_b16 a[138:139], v8 offset:53248
  v_mfma_f32_16x16x32_bf16 a[124:127], a[240:243], v[112:115], a[124:127]
  ds_read_b64_tr_b16 a[184:185], v11 offset:49152
  ds_read_b64_tr_b16 a[186:187], v11 offset:53248
  v_mfma_f32_16x16x32_bf16 a[124:127], a[244:247], v[116:119], a[124:127]
  ds_read_b64_tr_b16 a[148:149], v9 offset:40960
  ds_read_b64_tr_b16 a[150:151], v9 offset:45056
  v_mfma_f32_16x16x32_bf16 a[124:127], a[248:251], v[120:123], a[124:127]
  ds_read_b64_tr_b16 a[192:193], v12 offset:32768
  ds_read_b64_tr_b16 a[194:195], v12 offset:36864
  v_mfma_f32_16x16x32_bf16 a[124:127], a[252:255], v[124:127], a[124:127]
  ds_read_b64_tr_b16 a[168:169], v10 offset:49152
  ds_read_b64_tr_b16 a[170:171], v10 offset:53248
  v_mfma_f32_16x16x32_bf16 a[60:63], a[240:243], v[80:83], a[60:63]
  ds_read_b64_tr_b16 a[220:221], v13 offset:57344
  ds_read_b64_tr_b16 a[222:223], v13 offset:61440
  v_mfma_f32_16x16x32_bf16 a[60:63], a[244:247], v[84:87], a[60:63]
  ds_read_b64_tr_b16 a[140:141], v8 offset:57344
  ds_read_b64_tr_b16 a[142:143], v8 offset:61440
  v_mfma_f32_16x16x32_bf16 a[60:63], a[248:251], v[88:91], a[60:63]
  ds_read_b64_tr_b16 a[180:181], v11 offset:40960
  ds_read_b64_tr_b16 a[182:183], v11 offset:45056
  v_mfma_f32_16x16x32_bf16 a[60:63], a[252:255], v[92:95], a[60:63]
  ds_read_b64_tr_b16 a[144:145], v9 offset:32768
  ds_read_b64_tr_b16 a[146:147], v9 offset:36864
  v_mfma_f32_16x16x32_bf16 a[24:27], a[224:227], v[64:67], a[24:27]
  ds_read_b64_tr_b16 a[196:197], v12 offset:40960
  ds_read_b64_tr_b16 a[198:199], v12 offset:45056
  v_mfma_f32_16x16x32_bf16 a[24:27], a[228:231], v[68:71], a[24:27]
  ds_read_b64_tr_b16 a[172:173], v10 offset:57344
  ds_read_b64_tr_b16 a[174:175], v10 offset:61440
  v_mfma_f32_16x16x32_bf16 a[24:27], a[232:235], v[72:75], a[24:27]
  ds_read_b64_tr_b16 a[216:217], v13 offset:49152
  ds_read_b64_tr_b16 a[218:219], v13 offset:53248
  v_mfma_f32_16x16x32_bf16 a[24:27], a[236:239], v[76:79], a[24:27]
  ds_read_b64_tr_b16 a[176:177], v11 offset:32768
  ds_read_b64_tr_b16 a[178:179], v11 offset:36864
  v_mfma_f32_16x16x32_bf16 a[88:91], a[224:227], v[96:99], a[88:91]
  ds_read_b64_tr_b16 a[224:225], v14 offset:32768
  ds_read_b64_tr_b16 a[226:227], v14 offset:36864
  v_mfma_f32_16x16x32_bf16 a[88:91], a[228:231], v[100:103], a[88:91]
  ds_read_b64_tr_b16 a[228:229], v14 offset:40960
  ds_read_b64_tr_b16 a[230:231], v14 offset:45056
  v_mfma_f32_16x16x32_bf16 a[88:91], a[232:235], v[104:107], a[88:91]
  ds_read_b64_tr_b16 a[200:201], v12 offset:49152
  ds_read_b64_tr_b16 a[202:203], v12 offset:53248
  v_mfma_f32_16x16x32_bf16 a[88:91], a[236:239], v[108:111], a[88:91]
  ds_read_b64_tr_b16 a[212:213], v13 offset:40960
  ds_read_b64_tr_b16 a[214:215], v13 offset:45056
  v_mfma_f32_16x16x32_bf16 a[92:95], a[252:255], v[108:111], a[92:95]
  ds_read_b64_tr_b16 a[232:233], v14 offset:49152
  ds_read_b64_tr_b16 a[234:235], v14 offset:53248
  v_mfma_f32_16x16x32_bf16 a[92:95], a[248:251], v[104:107], a[92:95]
  ds_read_b64_tr_b16 a[204:205], v12 offset:57344
  ds_read_b64_tr_b16 a[206:207], v12 offset:61440
  v_mfma_f32_16x16x32_bf16 a[92:95], a[244:247], v[100:103], a[92:95]
  ds_read_b64_tr_b16 a[208:209], v13 offset:32768
  ds_read_b64_tr_b16 a[210:211], v13 offset:36864
  v_mfma_f32_16x16x32_bf16 a[92:95], a[240:243], v[96:99], a[92:95]
  ds_read_b64_tr_b16 a[236:237], v14 offset:57344
  ds_read_b64_tr_b16 a[238:239], v14 offset:61440
  v_mfma_f32_16x16x32_bf16 a[28:31], a[252:255], v[76:79], a[28:31]
  ds_read_b64_tr_b16 a[252:253], v15 offset:57344
  ds_read_b64_tr_b16 a[254:255], v15 offset:61440
  v_mfma_f32_16x16x32_bf16 a[28:31], a[248:251], v[72:75], a[28:31]
  ds_read_b64_tr_b16 a[248:249], v15 offset:49152
  ds_read_b64_tr_b16 a[250:251], v15 offset:53248
  v_mfma_f32_16x16x32_bf16 a[28:31], a[244:247], v[68:71], a[28:31]
  ds_read_b64_tr_b16 a[244:245], v15 offset:40960
  ds_read_b64_tr_b16 a[246:247], v15 offset:45056
  v_mfma_f32_16x16x32_bf16 a[28:31], a[240:243], v[64:67], a[28:31]
  s_waitcnt lgkmcnt(15)
  ds_read_b64_tr_b16 a[240:241], v15 offset:32768
  ds_read_b64_tr_b16 a[242:243], v15 offset:36864
  v_mfma_f32_16x16x32_bf16 a[0:3], a[128:131], v[128:131], a[0:3]
  v_exp_f32 v140, v140
  v_mfma_f32_16x16x32_bf16 a[0:3], a[132:135], v[132:135], a[0:3]
  v_exp_f32 v141, v141
  v_mfma_f32_16x16x32_bf16 a[0:3], a[136:139], v[136:139], a[0:3]
  v_add_f32 v28, v28, v140
  v_exp_f32 v142, v142
  v_mfma_f32_16x16x32_bf16 a[8:11], a[160:163], v[128:131], a[8:11]
  v_add_f32 v28, v28, v141
  v_exp_f32 v143, v143
  v_mfma_f32_16x16x32_bf16 a[8:11], a[164:167], v[132:135], a[8:11]
  v_add_f32 v28, v28, v142
  v_exp_f32 v240, v240
  v_mfma_f32_16x16x32_bf16 a[8:11], a[168:171], v[136:139], a[8:11]
  v_add_f32 v28, v28, v143
  v_exp_f32 v241, v241
  v_mfma_f32_16x16x32_bf16 a[16:19], a[192:195], v[128:131], a[16:19]
  v_add_f32 v28, v28, v240
  v_exp_f32 v242, v242
  v_mfma_f32_16x16x32_bf16 a[16:19], a[196:199], v[132:135], a[16:19]
  v_add_f32 v28, v28, v241
  v_exp_f32 v243, v243
  v_mfma_f32_16x16x32_bf16 a[16:19], a[200:203], v[136:139], a[16:19]
  v_cvt_pk_bf16_f32 v140, v140, v141
  v_add_f32 v28, v28, v242
  v_mfma_f32_16x16x32_bf16 a[24:27], a[224:227], v[128:131], a[24:27]
  v_cvt_pk_bf16_f32 v141, v142, v143
  v_cvt_pk_bf16_f32 v142, v240, v241
  v_mfma_f32_16x16x32_bf16 a[24:27], a[228:231], v[132:135], a[24:27]
  s_waitcnt lgkmcnt(0)
  v_add_f32 v28, v28, v243
  v_cvt_pk_bf16_f32 v143, v242, v243
  v_mfma_f32_16x16x32_bf16 a[24:27], a[232:235], v[136:139], a[24:27]
  v_mov_b32 v56, v28
  v_mov_b32 v48, v0
  v_mfma_f32_16x16x32_bf16 a[24:27], a[236:239], v[140:143], a[24:27]
  v_permlane32_swap_b32 v28, v56
  v_xor_b32 v49, 32, v0
  v_mfma_f32_16x16x32_bf16 a[4:7], a[156:159], v[140:143], a[4:7]
  v_add_f32 v28, v28, v56
  v_xor_b32 v50, 64, v0
  v_mfma_f32_16x16x32_bf16 a[4:7], a[152:155], v[136:139], a[4:7]
  v_mov_b32 v56, v28
  v_xor_b32 v51, 96, v0
  v_mfma_f32_16x16x32_bf16 a[4:7], a[148:151], v[132:135], a[4:7]
  v_permlane16_swap_b32 v28, v56
  v_xor_b32 v52, 128, v0
  v_mfma_f32_16x16x32_bf16 a[4:7], a[144:147], v[128:131], a[4:7]
  v_add_f32 v28, v28, v56
  v_xor_b32 v53, 160, v0
  v_mfma_f32_16x16x32_bf16 a[12:15], a[188:191], v[140:143], a[12:15]
  v_add_f32 v28, v28, v32
  v_mbcnt_lo_u32_b32 v57, -1, 0
  v_mfma_f32_16x16x32_bf16 a[12:15], a[184:187], v[136:139], a[12:15]
  v_add_f32 v28, v28, v33
  s_nop 0
  v_accvgpr_read_b32 v68, a4
  v_mfma_f32_16x16x32_bf16 a[12:15], a[180:183], v[132:135], a[12:15]
  v_cmp_gt_f32 s[84:85], s38, v28
  v_rcp_f32 v28, v28
  v_mfma_f32_16x16x32_bf16 a[12:15], a[176:179], v[128:131], a[12:15]
  v_accvgpr_read_b32 v69, a5
  v_accvgpr_read_b32 v70, a6
  v_mfma_f32_16x16x32_bf16 a[20:23], a[220:223], v[140:143], a[20:23]
  v_accvgpr_read_b32 v71, a7
  v_mul_f32 v68, v28, v68
  v_mfma_f32_16x16x32_bf16 a[20:23], a[216:219], v[136:139], a[20:23]
  v_mul_f32 v69, v28, v69
  s_nop 0
  v_accvgpr_read_b32 v76, a12
  v_mfma_f32_16x16x32_bf16 a[20:23], a[212:215], v[132:135], a[20:23]
  v_accvgpr_read_b32 v77, a13
  v_mul_f32 v70, v28, v70
  v_mfma_f32_16x16x32_bf16 a[20:23], a[208:211], v[128:131], a[20:23]
  v_mul_f32 v71, v28, v71
  v_cvt_pk_bf16_f32 v68, v68, v69
  v_mfma_f32_16x16x32_bf16 a[0:3], a[140:143], v[140:143], a[0:3]
  v_accvgpr_read_b32 v78, a14
  v_accvgpr_read_b32 v79, a15
  v_mfma_f32_16x16x32_bf16 a[28:31], a[252:255], v[140:143], a[28:31]
  v_mul_f32 v76, v28, v76
  v_mul_f32 v77, v28, v77
  v_mfma_f32_16x16x32_bf16 a[28:31], a[248:251], v[136:139], a[28:31]
  v_cvt_pk_bf16_f32 v69, v70, v71
  s_nop 0
  v_accvgpr_read_b32 v64, a0
  v_mfma_f32_16x16x32_bf16 a[28:31], a[244:247], v[132:135], a[28:31]
  v_accvgpr_read_b32 v65, a1
  v_accvgpr_read_b32 v66, a2
  v_mfma_f32_16x16x32_bf16 a[28:31], a[240:243], v[128:131], a[28:31]
  v_accvgpr_read_b32 v67, a3
  v_mul_f32 v64, v28, v64
  v_mfma_f32_16x16x32_bf16 a[8:11], a[172:175], v[140:143], a[8:11]
  v_mul_f32 v65, v28, v65
  v_mul_f32 v66, v28, v66
  v_mfma_f32_16x16x32_bf16 a[16:19], a[204:207], v[140:143], a[16:19]
  v_mul_f32 v67, v28, v67
  v_cvt_pk_bf16_f32 v64, v64, v65
  v_smfmac_f32_16x16x64_bf16 v[36:39], v[24:27], v[144:151], v23
  s_nop 1
  v_accvgpr_read_b32 v72, a8
  v_mfma_f32_16x16x32_bf16 a[32:35], a[128:131], v[144:147], a[32:35]
  v_accvgpr_read_b32 v73, a9
  v_accvgpr_read_b32 v74, a10
  v_mfma_f32_16x16x32_bf16 a[32:35], a[132:135], v[148:151], a[32:35]
  v_accvgpr_read_b32 v75, a11
  v_mul_f32 v72, v28, v72
  v_mfma_f32_16x16x32_bf16 a[32:35], a[136:139], v[152:155], a[32:35]
  v_mul_f32 v73, v28, v73
  v_cvt_pk_bf16_f32 v65, v66, v67
  v_mfma_f32_16x16x32_bf16 a[40:43], a[160:163], v[144:147], a[40:43]
  ds_write_b64 v48, v[64:65] offset:0
  v_mfma_f32_16x16x32_bf16 a[40:43], a[164:167], v[148:151], a[40:43]
  ds_write_b64 v49, v[68:69] offset:0
  v_mfma_f32_16x16x32_bf16 a[40:43], a[168:171], v[152:155], a[40:43]
  v_mul_f32 v74, v28, v74
  v_mul_f32 v75, v28, v75
  v_mfma_f32_16x16x32_bf16 a[48:51], a[192:195], v[144:147], a[48:51]
  v_cvt_pk_bf16_f32 v72, v72, v73
  v_mul_f32 v78, v28, v78
  v_mfma_f32_16x16x32_bf16 a[48:51], a[196:199], v[148:151], a[48:51]
  v_mul_f32 v79, v28, v79
  v_cvt_pk_bf16_f32 v73, v74, v75
  v_mfma_f32_16x16x32_bf16 a[48:51], a[200:203], v[152:155], a[48:51]
  ds_write_b64 v50, v[72:73] offset:0
  v_mfma_f32_16x16x32_bf16 a[56:59], a[224:227], v[144:147], a[56:59]
  v_cvt_pk_bf16_f32 v76, v76, v77
  v_cvt_pk_bf16_f32 v77, v78, v79
  v_mfma_f32_16x16x32_bf16 a[56:59], a[228:231], v[148:151], a[56:59]
  ds_write_b64 v51, v[76:77] offset:0
  v_mfma_f32_16x16x32_bf16 a[56:59], a[232:235], v[152:155], a[56:59]
  v_accvgpr_read_b32 v64, a16
  v_accvgpr_read_b32 v65, a17
  v_accvgpr_read_b32 v66, a18
  v_accvgpr_read_b32 v67, a19
  v_accvgpr_read_b32 v68, a20
  v_accvgpr_read_b32 v69, a21
  v_mul_f32 v64, v28, v64
  v_mul_f32 v65, v28, v65
  v_accvgpr_read_b32 v70, a22
  v_accvgpr_read_b32 v71, a23
  v_accvgpr_read_b32 v72, a24
  v_accvgpr_read_b32 v73, a25
  v_mul_f32 v66, v28, v66
  v_mul_f32 v67, v28, v67
  v_mul_f32 v68, v28, v68
  v_mul_f32 v69, v28, v69
  v_cvt_pk_bf16_f32 v64, v64, v65
  v_accvgpr_read_b32 v74, a26
  v_accvgpr_read_b32 v75, a27
  v_accvgpr_read_b32 v76, a28
  v_accvgpr_read_b32 v77, a29
  v_mul_f32 v70, v28, v70
  v_mul_f32 v71, v28, v71
  v_mul_f32 v72, v28, v72
  v_mul_f32 v73, v28, v73
  v_cvt_pk_bf16_f32 v65, v66, v67
  v_cvt_pk_bf16_f32 v68, v68, v69
  v_accvgpr_read_b32 v78, a30
  v_accvgpr_read_b32 v79, a31
  v_mul_f32 v74, v28, v74
  v_mul_f32 v75, v28, v75
  v_mul_f32 v76, v28, v76
  v_mul_f32 v77, v28, v77
  v_cvt_pk_bf16_f32 v69, v70, v71
  v_cvt_pk_bf16_f32 v72, v72, v73
  v_mul_f32 v78, v28, v78
  v_mul_f32 v79, v28, v79
  v_xor_b32 v54, 192, v0
  v_cvt_pk_bf16_f32 v73, v74, v75
  v_cvt_pk_bf16_f32 v76, v76, v77
  v_mbcnt_hi_u32_b32 v57, -1, v57
  v_xor_b32 v55, 224, v0
  v_cvt_pk_bf16_f32 v77, v78, v79
  v_lshl_add_u32 v57, v57, 4, s82
  v_exp_f32 v244, v244
  v_exp_f32 v245, v245
  v_exp_f32 v246, v246
  v_exp_f32 v247, v247
  v_cvt_pk_bf16_f32 v158, v244, v245
  v_cvt_pk_bf16_f32 v159, v246, v247
  v_smfmac_f32_16x16x64_bf16 v[40:43], v[24:27], v[160:167], v23
  ds_write_b64 v52, v[64:65] offset:0
  v_mfma_f32_16x16x32_bf16 a[36:39], a[156:159], v[156:159], a[36:39]
  ds_write_b64 v53, v[68:69] offset:0
  v_mfma_f32_16x16x32_bf16 a[36:39], a[152:155], v[152:155], a[36:39]
  ds_write_b64 v54, v[72:73] offset:0
  v_mfma_f32_16x16x32_bf16 a[36:39], a[148:151], v[148:151], a[36:39]
  ds_write_b64 v55, v[76:77] offset:0
  v_mfma_f32_16x16x32_bf16 a[36:39], a[144:147], v[144:147], a[36:39]
  ds_read_b128 v[80:83], v57 offset:0
  ds_read_b128 v[84:87], v57 offset:1024
  v_smfmac_f32_16x16x64_bf16 v[36:39], v[24:27], v[152:159], v23
  ds_read_b128 v[88:91], v57 offset:2048
  v_mfma_f32_16x16x32_bf16 a[44:47], a[188:191], v[156:159], a[44:47]
  ds_read_b128 v[92:95], v57 offset:3072
  s_nop 1
  v_accvgpr_read_b32 v100, a36
  v_mfma_f32_16x16x32_bf16 a[44:47], a[184:187], v[152:155], a[44:47]
  v_accvgpr_read_b32 v101, a37
  v_accvgpr_read_b32 v102, a38
  v_mfma_f32_16x16x32_bf16 a[44:47], a[180:183], v[148:151], a[44:47]
  v_accvgpr_read_b32 v103, a39
  s_nop 0
  v_add_f32 v29, v36, v37
  v_mfma_f32_16x16x32_bf16 a[44:47], a[176:179], v[144:147], a[44:47]
  v_cmp_gt_f32 s[86:87], s38, v29
  v_rcp_f32 v29, v29
  v_mfma_f32_16x16x32_bf16 a[52:55], a[220:223], v[156:159], a[52:55]
  v_mul_f32 v100, v29, v100
  v_mul_f32 v101, v29, v101
  v_mfma_f32_16x16x32_bf16 a[52:55], a[216:219], v[152:155], a[52:55]
  s_nop 1
  v_accvgpr_read_b32 v108, a44
  v_accvgpr_read_b32 v109, a45
  v_mfma_f32_16x16x32_bf16 a[52:55], a[212:215], v[148:151], a[52:55]
  v_mul_f32 v102, v29, v102
  v_mul_f32 v103, v29, v103
  v_mfma_f32_16x16x32_bf16 a[52:55], a[208:211], v[144:147], a[52:55]
  v_cvt_pk_bf16_f32 v100, v100, v101
  v_accvgpr_read_b32 v110, a46
  v_mfma_f32_16x16x32_bf16 a[32:35], a[140:143], v[156:159], a[32:35]
  s_waitcnt lgkmcnt(1)
  buffer_store_dwordx4 v[80:83], v16, s[24:27], s3 offen sc1
  v_mfma_f32_16x16x32_bf16 a[60:63], a[252:255], v[156:159], a[60:63]
  buffer_store_dwordx4 v[84:87], v17, s[24:27], s3 offen offset:1024 sc1
  v_mfma_f32_16x16x32_bf16 a[60:63], a[248:251], v[152:155], a[60:63]
  s_nop 2
  v_accvgpr_read_b32 v96, a32
  v_accvgpr_read_b32 v97, a33
  v_mfma_f32_16x16x32_bf16 a[60:63], a[244:247], v[148:151], a[60:63]
  v_accvgpr_read_b32 v98, a34
  v_accvgpr_read_b32 v99, a35
  v_mfma_f32_16x16x32_bf16 a[60:63], a[240:243], v[144:147], a[60:63]
  buffer_store_dwordx4 v[88:91], v18, s[24:27], s3 offen offset:2048 sc1
  v_mfma_f32_16x16x32_bf16 a[40:43], a[172:175], v[156:159], a[40:43]
  v_mul_f32 v96, v29, v96
  v_mul_f32 v97, v29, v97
  v_mfma_f32_16x16x32_bf16 a[48:51], a[204:207], v[156:159], a[48:51]
  v_mul_f32 v98, v29, v98
  v_mul_f32 v99, v29, v99
  v_mfma_f32_16x16x32_bf16 a[56:59], a[236:239], v[156:159], a[56:59]
  v_cvt_pk_bf16_f32 v96, v96, v97
  s_nop 0
  v_accvgpr_read_b32 v104, a40
  v_mfma_f32_16x16x32_bf16 a[64:67], a[128:131], v[160:163], a[64:67]
  s_waitcnt lgkmcnt(0)
  buffer_store_dwordx4 v[92:95], v19, s[24:27], s3 offen offset:3072 sc1
  v_mfma_f32_16x16x32_bf16 a[64:67], a[132:135], v[164:167], a[64:67]
  v_accvgpr_read_b32 v105, a41
  v_accvgpr_read_b32 v106, a42
  v_mfma_f32_16x16x32_bf16 a[64:67], a[136:139], v[168:171], a[64:67]
  v_accvgpr_read_b32 v107, a43
  v_mul_f32 v104, v29, v104
  v_mfma_f32_16x16x32_bf16 a[72:75], a[160:163], v[160:163], a[72:75]
  v_mul_f32 v105, v29, v105
  v_cvt_pk_bf16_f32 v97, v98, v99
  v_mfma_f32_16x16x32_bf16 a[72:75], a[164:167], v[164:167], a[72:75]
  ds_write_b64 v48, v[96:97] offset:4096
  v_mfma_f32_16x16x32_bf16 a[72:75], a[168:171], v[168:171], a[72:75]
  v_accvgpr_read_b32 v111, a47
  v_mul_f32 v106, v29, v106
  v_mfma_f32_16x16x32_bf16 a[80:83], a[192:195], v[160:163], a[80:83]
  v_mul_f32 v107, v29, v107
  v_mul_f32 v108, v29, v108
  v_mfma_f32_16x16x32_bf16 a[80:83], a[196:199], v[164:167], a[80:83]
  v_mul_f32 v109, v29, v109
  v_cvt_pk_bf16_f32 v101, v102, v103
  v_mfma_f32_16x16x32_bf16 a[80:83], a[200:203], v[168:171], a[80:83]
  ds_write_b64 v49, v[100:101] offset:4096
  v_mfma_f32_16x16x32_bf16 a[88:91], a[224:227], v[160:163], a[88:91]
  v_cvt_pk_bf16_f32 v104, v104, v105
  v_mul_f32 v110, v29, v110
  v_mfma_f32_16x16x32_bf16 a[88:91], a[228:231], v[164:167], a[88:91]
  v_mul_f32 v111, v29, v111
  v_cvt_pk_bf16_f32 v105, v106, v107
  v_mfma_f32_16x16x32_bf16 a[88:91], a[232:235], v[168:171], a[88:91]
  ds_write_b64 v50, v[104:105] offset:4096
  v_cvt_pk_bf16_f32 v108, v108, v109
  v_cvt_pk_bf16_f32 v109, v110, v111
  v_accvgpr_read_b32 v96, a48
  v_accvgpr_read_b32 v97, a49
  v_accvgpr_read_b32 v98, a50
  v_accvgpr_read_b32 v99, a51
  v_accvgpr_read_b32 v100, a52
  v_accvgpr_read_b32 v101, a53
  v_mul_f32 v96, v29, v96
  v_mul_f32 v97, v29, v97
  v_accvgpr_read_b32 v102, a54
  v_accvgpr_read_b32 v103, a55
  v_accvgpr_read_b32 v104, a56
  v_accvgpr_read_b32 v105, a57
  v_mul_f32 v98, v29, v98
  v_mul_f32 v99, v29, v99
  v_mul_f32 v100, v29, v100
  v_mul_f32 v101, v29, v101
  v_cvt_pk_bf16_f32 v96, v96, v97
  v_accvgpr_read_b32 v106, a58
  v_accvgpr_read_b32 v107, a59
  v_mul_f32 v102, v29, v102
  v_mul_f32 v103, v29, v103
  v_mul_f32 v104, v29, v104
  v_mul_f32 v105, v29, v105
  v_cvt_pk_bf16_f32 v97, v98, v99
  v_cvt_pk_bf16_f32 v100, v100, v101
  v_accvgpr_read_b32 v110, a62
  v_accvgpr_read_b32 v111, a63
  v_mul_f32 v106, v29, v106
  v_mul_f32 v107, v29, v107
  v_cvt_pk_bf16_f32 v101, v102, v103
  v_cvt_pk_bf16_f32 v104, v104, v105
  v_mul_f32 v110, v29, v110
  v_mul_f32 v111, v29, v111
  v_cvt_pk_bf16_f32 v105, v106, v107
  v_exp_f32 v248, v248
  v_exp_f32 v249, v249
  v_exp_f32 v250, v250
  v_exp_f32 v251, v251
  v_cvt_pk_bf16_f32 v174, v248, v249
  v_cvt_pk_bf16_f32 v175, v250, v251
  v_smfmac_f32_16x16x64_bf16 v[44:47], v[24:27], v[176:183], v23
  ds_write_b64 v51, v[108:109] offset:4096
  v_mfma_f32_16x16x32_bf16 a[68:71], a[156:159], v[172:175], a[68:71]
  ds_write_b64 v52, v[96:97] offset:4096
  v_mfma_f32_16x16x32_bf16 a[68:71], a[152:155], v[168:171], a[68:71]
  ds_write_b64 v53, v[100:101] offset:4096
  v_mfma_f32_16x16x32_bf16 a[68:71], a[148:151], v[164:167], a[68:71]
  ds_write_b64 v54, v[104:105] offset:4096
  v_mfma_f32_16x16x32_bf16 a[68:71], a[144:147], v[160:163], a[68:71]
  v_accvgpr_read_b32 v108, a60
  v_accvgpr_read_b32 v109, a61
  v_smfmac_f32_16x16x64_bf16 v[40:43], v[24:27], v[168:175], v23
  v_mul_f32 v108, v29, v108
  v_mfma_f32_16x16x32_bf16 a[76:79], a[188:191], v[172:175], a[76:79]
  v_mul_f32 v109, v29, v109
  s_nop 1
  v_accvgpr_read_b32 v68, a68
  v_mfma_f32_16x16x32_bf16 a[76:79], a[184:187], v[168:171], a[76:79]
  v_cvt_pk_bf16_f32 v108, v108, v109
  v_cvt_pk_bf16_f32 v109, v110, v111
  v_mfma_f32_16x16x32_bf16 a[76:79], a[180:183], v[164:167], a[76:79]
  ds_write_b64 v55, v[108:109] offset:4096
  v_mfma_f32_16x16x32_bf16 a[76:79], a[176:179], v[160:163], a[76:79]
  ds_read_b128 v[112:115], v57 offset:4096
  ds_read_b128 v[116:119], v57 offset:5120
  v_mfma_f32_16x16x32_bf16 a[84:87], a[220:223], v[172:175], a[84:87]
  ds_read_b128 v[120:123], v57 offset:6144
  ds_read_b128 v[124:127], v57 offset:7168
  v_mfma_f32_16x16x32_bf16 a[84:87], a[216:219], v[168:171], a[84:87]
  v_add_f32 v30, v40, v41
  v_accvgpr_read_b32 v69, a69
  v_mfma_f32_16x16x32_bf16 a[84:87], a[212:215], v[164:167], a[84:87]
  v_cmp_gt_f32 s[88:89], s38, v30
  v_rcp_f32 v30, v30
  v_mfma_f32_16x16x32_bf16 a[84:87], a[208:211], v[160:163], a[84:87]
  v_accvgpr_read_b32 v70, a70
  v_accvgpr_read_b32 v71, a71
  v_mfma_f32_16x16x32_bf16 a[64:67], a[140:143], v[172:175], a[64:67]
  v_mul_f32 v68, v30, v68
  v_mul_f32 v69, v30, v69
  v_mfma_f32_16x16x32_bf16 a[92:95], a[252:255], v[172:175], a[92:95]
  v_accvgpr_read_b32 v76, a76
  v_accvgpr_read_b32 v77, a77
  v_mfma_f32_16x16x32_bf16 a[92:95], a[248:251], v[168:171], a[92:95]
  v_mul_f32 v70, v30, v70
  s_nop 0
  v_accvgpr_read_b32 v64, a64
  v_mfma_f32_16x16x32_bf16 a[92:95], a[244:247], v[164:167], a[92:95]
  v_accvgpr_read_b32 v65, a65
  v_accvgpr_read_b32 v66, a66
  v_mfma_f32_16x16x32_bf16 a[92:95], a[240:243], v[160:163], a[92:95]
  s_waitcnt lgkmcnt(3)
  buffer_store_dwordx4 v[112:115], v16, s[24:27], s33 offen sc1
  v_mfma_f32_16x16x32_bf16 a[72:75], a[172:175], v[172:175], a[72:75]
  s_waitcnt lgkmcnt(2)
  buffer_store_dwordx4 v[116:119], v17, s[24:27], s33 offen offset:1024 sc1
  v_mfma_f32_16x16x32_bf16 a[80:83], a[204:207], v[172:175], a[80:83]
  v_accvgpr_read_b32 v67, a67
  v_mul_f32 v64, v30, v64
  v_mfma_f32_16x16x32_bf16 a[88:91], a[236:239], v[172:175], a[88:91]
  v_mul_f32 v65, v30, v65
  s_nop 0
  v_accvgpr_read_b32 v72, a72
  v_mfma_f32_16x16x32_bf16 a[96:99], a[128:131], v[176:179], a[96:99]
  s_waitcnt lgkmcnt(0)
  buffer_store_dwordx4 v[120:123], v18, s[24:27], s33 offen offset:2048 sc1
  v_mfma_f32_16x16x32_bf16 a[96:99], a[132:135], v[180:183], a[96:99]
  v_accvgpr_read_b32 v73, a73
  v_mul_f32 v66, v30, v66
  v_mfma_f32_16x16x32_bf16 a[96:99], a[136:139], v[184:187], a[96:99]
  v_mul_f32 v67, v30, v67
  v_cvt_pk_bf16_f32 v64, v64, v65
  v_mfma_f32_16x16x32_bf16 a[104:107], a[160:163], v[176:179], a[104:107]
  v_accvgpr_read_b32 v74, a74
  v_accvgpr_read_b32 v75, a75
  v_mfma_f32_16x16x32_bf16 a[104:107], a[164:167], v[180:183], a[104:107]
  buffer_store_dwordx4 v[124:127], v19, s[24:27], s33 offen offset:3072 sc1
  v_mfma_f32_16x16x32_bf16 a[104:107], a[168:171], v[184:187], a[104:107]
  v_mul_f32 v71, v30, v71
  v_mul_f32 v72, v30, v72
  v_mfma_f32_16x16x32_bf16 a[112:115], a[192:195], v[176:179], a[112:115]
  v_mul_f32 v73, v30, v73
  v_cvt_pk_bf16_f32 v65, v66, v67
  v_mfma_f32_16x16x32_bf16 a[112:115], a[196:199], v[180:183], a[112:115]
  ds_write_b64 v48, v[64:65] offset:8192
  v_mfma_f32_16x16x32_bf16 a[112:115], a[200:203], v[184:187], a[112:115]
  v_cvt_pk_bf16_f32 v68, v68, v69
  v_accvgpr_read_b32 v78, a78
  v_mfma_f32_16x16x32_bf16 a[120:123], a[224:227], v[176:179], a[120:123]
  v_accvgpr_read_b32 v79, a79
  v_mul_f32 v74, v30, v74
  v_mfma_f32_16x16x32_bf16 a[120:123], a[228:231], v[180:183], a[120:123]
L_pad5:
  s_cbranch_execz L_back
  v_mul_f32 v75, v30, v75
  v_mul_f32 v76, v30, v76
  v_mfma_f32_16x16x32_bf16 a[120:123], a[232:235], v[184:187], a[120:123]
  v_mul_f32 v77, v30, v77
  v_cvt_pk_bf16_f32 v69, v70, v71
  v_cvt_pk_bf16_f32 v72, v72, v73
  v_mul_f32 v78, v30, v78
  v_mul_f32 v79, v30, v79
  v_cvt_pk_bf16_f32 v73, v74, v75
  v_cvt_pk_bf16_f32 v76, v76, v77
  v_cvt_pk_bf16_f32 v77, v78, v79
  v_accvgpr_read_b32 v64, a80
  v_accvgpr_read_b32 v65, a81
  v_accvgpr_read_b32 v66, a82
  v_accvgpr_read_b32 v67, a83
  v_mul_f32 v64, v30, v64
  v_mul_f32 v65, v30, v65
  v_accvgpr_read_b32 v70, a86
  v_accvgpr_read_b32 v71, a87
  v_mul_f32 v66, v30, v66
  v_mul_f32 v67, v30, v67
  v_cvt_pk_bf16_f32 v64, v64, v65
  v_accvgpr_read_b32 v74, a90
  v_accvgpr_read_b32 v75, a91
  v_mul_f32 v70, v30, v70
  v_mul_f32 v71, v30, v71
  v_cvt_pk_bf16_f32 v65, v66, v67
  v_accvgpr_read_b32 v78, a94
  v_accvgpr_read_b32 v79, a95
  v_mul_f32 v74, v30, v74
  v_mul_f32 v75, v30, v75
  v_mul_f32 v78, v30, v78
  v_mul_f32 v79, v30, v79
  v_exp_f32 v252, v252
  v_exp_f32 v253, v253
  v_exp_f32 v254, v254
  v_exp_f32 v255, v255
  v_cvt_pk_bf16_f32 v190, v252, v253
  v_cvt_pk_bf16_f32 v191, v254, v255
  s_nop 1
  v_mfma_f32_16x16x32_bf16 a[120:123], a[236:239], v[188:191], a[120:123]
  ds_write_b64 v49, v[68:69] offset:8192
  ds_write_b64 v50, v[72:73] offset:8192
  ds_write_b64 v51, v[76:77] offset:8192
  v_mfma_f32_16x16x32_bf16 a[100:103], a[156:159], v[188:191], a[100:103]
  ds_write_b64 v52, v[64:65] offset:8192
  v_mfma_f32_16x16x32_bf16 a[100:103], a[152:155], v[184:187], a[100:103]
  v_accvgpr_read_b32 v68, a84
  v_accvgpr_read_b32 v69, a85
  v_mfma_f32_16x16x32_bf16 a[100:103], a[148:151], v[180:183], a[100:103]
  v_accvgpr_read_b32 v72, a88
  v_accvgpr_read_b32 v73, a89
  v_mfma_f32_16x16x32_bf16 a[100:103], a[144:147], v[176:179], a[100:103]
  v_mul_f32 v68, v30, v68
  v_mul_f32 v69, v30, v69
  v_smfmac_f32_16x16x64_bf16 v[44:47], v[24:27], v[184:191], v23
  v_accvgpr_read_b32 v76, a92
  v_mfma_f32_16x16x32_bf16 a[108:111], a[188:191], v[188:191], a[108:111]
  v_accvgpr_read_b32 v77, a93
  v_mul_f32 v72, v30, v72
  v_mfma_f32_16x16x32_bf16 a[108:111], a[184:187], v[184:187], a[108:111]
  v_mul_f32 v73, v30, v73
  v_cvt_pk_bf16_f32 v68, v68, v69
  v_mfma_f32_16x16x32_bf16 a[108:111], a[180:183], v[180:183], a[108:111]
  v_mul_f32 v76, v30, v76
  v_mul_f32 v77, v30, v77
  v_mfma_f32_16x16x32_bf16 a[108:111], a[176:179], v[176:179], a[108:111]
  v_cvt_pk_bf16_f32 v69, v70, v71
  v_cvt_pk_bf16_f32 v72, v72, v73
  v_mfma_f32_16x16x32_bf16 a[116:119], a[220:223], v[188:191], a[116:119]
  ds_write_b64 v53, v[68:69] offset:8192
  v_mfma_f32_16x16x32_bf16 a[116:119], a[216:219], v[184:187], a[116:119]
  v_cvt_pk_bf16_f32 v73, v74, v75
  v_cvt_pk_bf16_f32 v76, v76, v77
  v_mfma_f32_16x16x32_bf16 a[116:119], a[212:215], v[180:183], a[116:119]
  ds_write_b64 v54, v[72:73] offset:8192
  v_mfma_f32_16x16x32_bf16 a[116:119], a[208:211], v[176:179], a[116:119]
  v_cvt_pk_bf16_f32 v77, v78, v79
  v_add_f32 v31, v44, v45
  v_mfma_f32_16x16x32_bf16 a[96:99], a[140:143], v[188:191], a[96:99]
  ds_write_b64 v55, v[76:77] offset:8192
  ds_read_b128 v[80:83], v57 offset:8192
  v_mfma_f32_16x16x32_bf16 a[124:127], a[252:255], v[188:191], a[124:127]
  ds_read_b128 v[84:87], v57 offset:9216
  ds_read_b128 v[88:91], v57 offset:10240
  v_mfma_f32_16x16x32_bf16 a[124:127], a[248:251], v[184:187], a[124:127]
  ds_read_b128 v[92:95], v57 offset:11264
  v_cmp_gt_f32 s[90:91], s38, v31
  v_mfma_f32_16x16x32_bf16 a[124:127], a[244:247], v[180:183], a[124:127]
  v_rcp_f32 v31, v31
  v_mfma_f32_16x16x32_bf16 a[124:127], a[240:243], v[176:179], a[124:127]
  v_accvgpr_read_b32 v96, a96
  v_accvgpr_read_b32 v97, a97
  v_mfma_f32_16x16x32_bf16 a[104:107], a[172:175], v[188:191], a[104:107]
  v_accvgpr_read_b32 v98, a98
  v_accvgpr_read_b32 v99, a99
  v_mfma_f32_16x16x32_bf16 a[112:115], a[204:207], v[188:191], a[112:115]
  v_accvgpr_read_b32 v100, a100
  v_accvgpr_read_b32 v101, a101
  v_accvgpr_read_b32 v102, a102
  v_accvgpr_read_b32 v103, a103
  v_accvgpr_read_b32 v108, a108
  v_pk_mul_f32 v[96:97], v[96:97], v[30:31] op_sel:[0,1] op_sel_hi:[1,1]
  v_accvgpr_read_b32 v104, a104
  v_accvgpr_read_b32 v105, a105
  v_pk_mul_f32 v[98:99], v[98:99], v[30:31] op_sel:[0,1] op_sel_hi:[1,1]
  v_pk_mul_f32 v[100:101], v[100:101], v[30:31] op_sel:[0,1] op_sel_hi:[1,1]
  v_cvt_pk_bf16_f32 v96, v96, v97
  v_accvgpr_read_b32 v106, a106
  v_accvgpr_read_b32 v107, a107
  v_accvgpr_read_b32 v109, a109
  v_pk_mul_f32 v[102:103], v[102:103], v[30:31] op_sel:[0,1] op_sel_hi:[1,1]
  v_pk_mul_f32 v[104:105], v[104:105], v[30:31] op_sel:[0,1] op_sel_hi:[1,1]
  v_cvt_pk_bf16_f32 v97, v98, v99
  v_cvt_pk_bf16_f32 v100, v100, v101
  v_accvgpr_read_b32 v110, a110
  v_accvgpr_read_b32 v111, a111
  v_pk_mul_f32 v[106:107], v[106:107], v[30:31] op_sel:[0,1] op_sel_hi:[1,1]
  v_pk_mul_f32 v[108:109], v[108:109], v[30:31] op_sel:[0,1] op_sel_hi:[1,1]
  v_cvt_pk_bf16_f32 v101, v102, v103
  v_cvt_pk_bf16_f32 v104, v104, v105
  v_pk_mul_f32 v[110:111], v[110:111], v[30:31] op_sel:[0,1] op_sel_hi:[1,1]
  v_cvt_pk_bf16_f32 v105, v106, v107
  v_cvt_pk_bf16_f32 v108, v108, v109
  v_cvt_pk_bf16_f32 v109, v110, v111
  v_accvgpr_read_b32 v98, a114
  v_accvgpr_read_b32 v99, a115
  v_accvgpr_read_b32 v102, a118
  v_accvgpr_read_b32 v103, a119
  v_pk_mul_f32 v[98:99], v[98:99], v[30:31] op_sel:[0,1] op_sel_hi:[1,1]
  v_accvgpr_read_b32 v106, a122
  v_accvgpr_read_b32 v107, a123
  v_pk_mul_f32 v[102:103], v[102:103], v[30:31] op_sel:[0,1] op_sel_hi:[1,1]
  v_accvgpr_read_b32 v110, a126
  v_accvgpr_read_b32 v111, a127
  v_pk_mul_f32 v[106:107], v[106:107], v[30:31] op_sel:[0,1] op_sel_hi:[1,1]
  v_pk_mul_f32 v[110:111], v[110:111], v[30:31] op_sel:[0,1] op_sel_hi:[1,1]
  s_waitcnt lgkmcnt(0)
  buffer_store_dwordx4 v[80:83], v16, s[24:27], s34 offen sc1
  buffer_store_dwordx4 v[84:87], v17, s[24:27], s34 offen offset:1024 sc1
  ds_write_b64 v48, v[96:97] offset:12288
  ds_write_b64 v49, v[100:101] offset:12288
  ds_write_b64 v50, v[104:105] offset:12288
  ds_write_b64 v51, v[108:109] offset:12288
  buffer_store_dwordx4 v[88:91], v18, s[24:27], s34 offen offset:2048 sc1
  v_accvgpr_read_b32 v96, a112
  v_accvgpr_read_b32 v97, a113
  v_accvgpr_read_b32 v100, a116
  v_accvgpr_read_b32 v101, a117
  v_pk_mul_f32 v[96:97], v[96:97], v[30:31] op_sel:[0,1] op_sel_hi:[1,1]
  v_accvgpr_read_b32 v104, a120
  v_accvgpr_read_b32 v105, a121
  v_pk_mul_f32 v[100:101], v[100:101], v[30:31] op_sel:[0,1] op_sel_hi:[1,1]
  v_cvt_pk_bf16_f32 v96, v96, v97
  v_accvgpr_read_b32 v108, a124
  v_accvgpr_read_b32 v109, a125
  v_pk_mul_f32 v[104:105], v[104:105], v[30:31] op_sel:[0,1] op_sel_hi:[1,1]
  v_cvt_pk_bf16_f32 v97, v98, v99
  v_cvt_pk_bf16_f32 v100, v100, v101
  v_pk_mul_f32 v[108:109], v[108:109], v[30:31] op_sel:[0,1] op_sel_hi:[1,1]
  v_cvt_pk_bf16_f32 v101, v102, v103
  v_cvt_pk_bf16_f32 v104, v104, v105
  v_cvt_pk_bf16_f32 v105, v106, v107
  v_cvt_pk_bf16_f32 v108, v108, v109
  v_cvt_pk_bf16_f32 v109, v110, v111
  ds_write_b64 v52, v[96:97] offset:12288
  ds_write_b64 v53, v[100:101] offset:12288
  ds_write_b64 v54, v[104:105] offset:12288
  ds_write_b64 v55, v[108:109] offset:12288
  ds_read_b128 v[112:115], v57 offset:12288
  buffer_store_dwordx4 v[92:95], v19, s[24:27], s34 offen offset:3072 sc1
  ds_read_b128 v[116:119], v57 offset:13312
  ds_read_b128 v[120:123], v57 offset:14336
  ds_read_b128 v[124:127], v57 offset:15360
  s_waitcnt lgkmcnt(3)
  buffer_store_dwordx4 v[112:115], v16, s[24:27], s35 offen sc1
  s_waitcnt lgkmcnt(2)
  buffer_store_dwordx4 v[116:119], v17, s[24:27], s35 offen offset:1024 sc1
  s_waitcnt lgkmcnt(1)
  buffer_store_dwordx4 v[120:123], v18, s[24:27], s35 offen offset:2048 sc1
  s_waitcnt lgkmcnt(0)
  buffer_store_dwordx4 v[124:127], v19, s[24:27], s35 offen offset:3072 sc1
  s_and_b64 s[84:85], s[84:85], s[86:87]
  s_and_b64 s[84:85], s[84:85], s[88:89]
  s_and_b64 s[84:85], s[84:85], s[90:91]
  s_cmp_eq_u64 s[84:85], -1
  s_cbranch_scc0 L_slow
L_end:
  s_endpgm
  L_slow:
  s_nop 15
  v_mov_b32 v192, 0
  v_accvgpr_read_b32 v196, a0
  v_fma_f32 v192, v196, 0, v192
  v_accvgpr_read_b32 v197, a1
  v_fma_f32 v192, v197, 0, v192
  v_accvgpr_read_b32 v198, a2
  v_fma_f32 v192, v198, 0, v192
  v_accvgpr_read_b32 v199, a3
  v_fma_f32 v192, v199, 0, v192
  v_accvgpr_read_b32 v196, a4
  v_fma_f32 v192, v196, 0, v192
  v_accvgpr_read_b32 v197, a5
  v_fma_f32 v192, v197, 0, v192
  v_accvgpr_read_b32 v198, a6
  v_fma_f32 v192, v198, 0, v192
  v_accvgpr_read_b32 v199, a7
  v_fma_f32 v192, v199, 0, v192
  v_accvgpr_read_b32 v196, a8
  v_fma_f32 v192, v196, 0, v192
  v_accvgpr_read_b32 v197, a9
  v_fma_f32 v192, v197, 0, v192
  v_accvgpr_read_b32 v198, a10
  v_fma_f32 v192, v198, 0, v192
  v_accvgpr_read_b32 v199, a11
  v_fma_f32 v192, v199, 0, v192
  v_accvgpr_read_b32 v196, a12
  v_fma_f32 v192, v196, 0, v192
  v_accvgpr_read_b32 v197, a13
  v_fma_f32 v192, v197, 0, v192
  v_accvgpr_read_b32 v198, a14
  v_fma_f32 v192, v198, 0, v192
  v_accvgpr_read_b32 v199, a15
  v_fma_f32 v192, v199, 0, v192
  v_accvgpr_read_b32 v196, a16
  v_fma_f32 v192, v196, 0, v192
  v_accvgpr_read_b32 v197, a17
  v_fma_f32 v192, v197, 0, v192
  v_accvgpr_read_b32 v198, a18
  v_fma_f32 v192, v198, 0, v192
  v_accvgpr_read_b32 v199, a19
  v_fma_f32 v192, v199, 0, v192
  v_accvgpr_read_b32 v196, a20
  v_fma_f32 v192, v196, 0, v192
  v_accvgpr_read_b32 v197, a21
  v_fma_f32 v192, v197, 0, v192
  v_accvgpr_read_b32 v198, a22
  v_fma_f32 v192, v198, 0, v192
  v_accvgpr_read_b32 v199, a23
  v_fma_f32 v192, v199, 0, v192
  v_accvgpr_read_b32 v196, a24
  v_fma_f32 v192, v196, 0, v192
  v_accvgpr_read_b32 v197, a25
  v_fma_f32 v192, v197, 0, v192
  v_accvgpr_read_b32 v198, a26
  v_fma_f32 v192, v198, 0, v192
  v_accvgpr_read_b32 v199, a27
  v_fma_f32 v192, v199, 0, v192
  v_accvgpr_read_b32 v196, a28
  v_fma_f32 v192, v196, 0, v192
  v_accvgpr_read_b32 v197, a29
  v_fma_f32 v192, v197, 0, v192
  v_accvgpr_read_b32 v198, a30
  v_fma_f32 v192, v198, 0, v192
  v_accvgpr_read_b32 v199, a31
  v_fma_f32 v192, v199, 0, v192
  v_accvgpr_read_b32 v196, a32
  v_fma_f32 v192, v196, 0, v192
  v_accvgpr_read_b32 v197, a33
  v_fma_f32 v192, v197, 0, v192
  v_accvgpr_read_b32 v198, a34
  v_fma_f32 v192, v198, 0, v192
  v_accvgpr_read_b32 v199, a35
  v_fma_f32 v192, v199, 0, v192
  v_accvgpr_read_b32 v196, a36
  v_fma_f32 v192, v196, 0, v192
  v_accvgpr_read_b32 v197, a37
  v_fma_f32 v192, v197, 0, v192
  v_accvgpr_read_b32 v198, a38
  v_fma_f32 v192, v198, 0, v192
  v_accvgpr_read_b32 v199, a39
  v_fma_f32 v192, v199, 0, v192
  v_accvgpr_read_b32 v196, a40
  v_fma_f32 v192, v196, 0, v192
  v_accvgpr_read_b32 v197, a41
  v_fma_f32 v192, v197, 0, v192
  v_accvgpr_read_b32 v198, a42
  v_fma_f32 v192, v198, 0, v192
  v_accvgpr_read_b32 v199, a43
  v_fma_f32 v192, v199, 0, v192
  v_accvgpr_read_b32 v196, a44
  v_fma_f32 v192, v196, 0, v192
  v_accvgpr_read_b32 v197, a45
  v_fma_f32 v192, v197, 0, v192
  v_accvgpr_read_b32 v198, a46
  v_fma_f32 v192, v198, 0, v192
  v_accvgpr_read_b32 v199, a47
  v_fma_f32 v192, v199, 0, v192
  v_accvgpr_read_b32 v196, a48
  v_fma_f32 v192, v196, 0, v192
  v_accvgpr_read_b32 v197, a49
  v_fma_f32 v192, v197, 0, v192
  v_accvgpr_read_b32 v198, a50
  v_fma_f32 v192, v198, 0, v192
  v_accvgpr_read_b32 v199, a51
  v_fma_f32 v192, v199, 0, v192
  v_accvgpr_read_b32 v196, a52
  v_fma_f32 v192, v196, 0, v192
  v_accvgpr_read_b32 v197, a53
  v_fma_f32 v192, v197, 0, v192
  v_accvgpr_read_b32 v198, a54
  v_fma_f32 v192, v198, 0, v192
  v_accvgpr_read_b32 v199, a55
  v_fma_f32 v192, v199, 0, v192
  v_accvgpr_read_b32 v196, a56
  v_fma_f32 v192, v196, 0, v192
  v_accvgpr_read_b32 v197, a57
  v_fma_f32 v192, v197, 0, v192
  v_accvgpr_read_b32 v198, a58
  v_fma_f32 v192, v198, 0, v192
  v_accvgpr_read_b32 v199, a59
  v_fma_f32 v192, v199, 0, v192
  v_accvgpr_read_b32 v196, a60
  v_fma_f32 v192, v196, 0, v192
  v_accvgpr_read_b32 v197, a61
  v_fma_f32 v192, v197, 0, v192
  v_accvgpr_read_b32 v198, a62
  v_fma_f32 v192, v198, 0, v192
  v_accvgpr_read_b32 v199, a63
  v_fma_f32 v192, v199, 0, v192
  v_accvgpr_read_b32 v196, a64
  v_fma_f32 v192, v196, 0, v192
  v_accvgpr_read_b32 v197, a65
  v_fma_f32 v192, v197, 0, v192
  v_accvgpr_read_b32 v198, a66
  v_fma_f32 v192, v198, 0, v192
  v_accvgpr_read_b32 v199, a67
  v_fma_f32 v192, v199, 0, v192
  v_accvgpr_read_b32 v196, a68
  v_fma_f32 v192, v196, 0, v192
  v_accvgpr_read_b32 v197, a69
  v_fma_f32 v192, v197, 0, v192
  v_accvgpr_read_b32 v198, a70
  v_fma_f32 v192, v198, 0, v192
  v_accvgpr_read_b32 v199, a71
  v_fma_f32 v192, v199, 0, v192
  v_accvgpr_read_b32 v196, a72
  v_fma_f32 v192, v196, 0, v192
  v_accvgpr_read_b32 v197, a73
  v_fma_f32 v192, v197, 0, v192
  v_accvgpr_read_b32 v198, a74
  v_fma_f32 v192, v198, 0, v192
  v_accvgpr_read_b32 v199, a75
  v_fma_f32 v192, v199, 0, v192
  v_accvgpr_read_b32 v196, a76
  v_fma_f32 v192, v196, 0, v192
  v_accvgpr_read_b32 v197, a77
  v_fma_f32 v192, v197, 0, v192
  v_accvgpr_read_b32 v198, a78
  v_fma_f32 v192, v198, 0, v192
  v_accvgpr_read_b32 v199, a79
  v_fma_f32 v192, v199, 0, v192
  v_accvgpr_read_b32 v196, a80
  v_fma_f32 v192, v196, 0, v192
  v_accvgpr_read_b32 v197, a81
  v_fma_f32 v192, v197, 0, v192
  v_accvgpr_read_b32 v198, a82
  v_fma_f32 v192, v198, 0, v192
  v_accvgpr_read_b32 v199, a83
  v_fma_f32 v192, v199, 0, v192
  v_accvgpr_read_b32 v196, a84
  v_fma_f32 v192, v196, 0, v192
  v_accvgpr_read_b32 v197, a85
  v_fma_f32 v192, v197, 0, v192
  v_accvgpr_read_b32 v198, a86
  v_fma_f32 v192, v198, 0, v192
  v_accvgpr_read_b32 v199, a87
  v_fma_f32 v192, v199, 0, v192
  v_accvgpr_read_b32 v196, a88
  v_fma_f32 v192, v196, 0, v192
  v_accvgpr_read_b32 v197, a89
  v_fma_f32 v192, v197, 0, v192
  v_accvgpr_read_b32 v198, a90
  v_fma_f32 v192, v198, 0, v192
  v_accvgpr_read_b32 v199, a91
  v_fma_f32 v192, v199, 0, v192
  v_accvgpr_read_b32 v196, a92
  v_fma_f32 v192, v196, 0, v192
  v_accvgpr_read_b32 v197, a93
  v_fma_f32 v192, v197, 0, v192
  v_accvgpr_read_b32 v198, a94
  v_fma_f32 v192, v198, 0, v192
  v_accvgpr_read_b32 v199, a95
  v_fma_f32 v192, v199, 0, v192
  v_accvgpr_read_b32 v196, a96
  v_fma_f32 v192, v196, 0, v192
  v_accvgpr_read_b32 v197, a97
  v_fma_f32 v192, v197, 0, v192
  v_accvgpr_read_b32 v198, a98
  v_fma_f32 v192, v198, 0, v192
  v_accvgpr_read_b32 v199, a99
  v_fma_f32 v192, v199, 0, v192
  v_accvgpr_read_b32 v196, a100
  v_fma_f32 v192, v196, 0, v192
  v_accvgpr_read_b32 v197, a101
  v_fma_f32 v192, v197, 0, v192
  v_accvgpr_read_b32 v198, a102
  v_fma_f32 v192, v198, 0, v192
  v_accvgpr_read_b32 v199, a103
  v_fma_f32 v192, v199, 0, v192
  v_accvgpr_read_b32 v196, a104
  v_fma_f32 v192, v196, 0, v192
  v_accvgpr_read_b32 v197, a105
  v_fma_f32 v192, v197, 0, v192
  v_accvgpr_read_b32 v198, a106
  v_fma_f32 v192, v198, 0, v192
  v_accvgpr_read_b32 v199, a107
  v_fma_f32 v192, v199, 0, v192
  v_accvgpr_read_b32 v196, a108
  v_fma_f32 v192, v196, 0, v192
  v_accvgpr_read_b32 v197, a109
  v_fma_f32 v192, v197, 0, v192
  v_accvgpr_read_b32 v198, a110
  v_fma_f32 v192, v198, 0, v192
  v_accvgpr_read_b32 v199, a111
  v_fma_f32 v192, v199, 0, v192
  v_accvgpr_read_b32 v196, a112
  v_fma_f32 v192, v196, 0, v192
  v_accvgpr_read_b32 v197, a113
  v_fma_f32 v192, v197, 0, v192
  v_accvgpr_read_b32 v198, a114
  v_fma_f32 v192, v198, 0, v192
  v_accvgpr_read_b32 v199, a115
  v_fma_f32 v192, v199, 0, v192
  v_accvgpr_read_b32 v196, a116
  v_fma_f32 v192, v196, 0, v192
  v_accvgpr_read_b32 v197, a117
  v_fma_f32 v192, v197, 0, v192
  v_accvgpr_read_b32 v198, a118
  v_fma_f32 v192, v198, 0, v192
  v_accvgpr_read_b32 v199, a119
  v_fma_f32 v192, v199, 0, v192
  v_accvgpr_read_b32 v196, a120
  v_fma_f32 v192, v196, 0, v192
  v_accvgpr_read_b32 v197, a121
  v_fma_f32 v192, v197, 0, v192
  v_accvgpr_read_b32 v198, a122
  v_fma_f32 v192, v198, 0, v192
  v_accvgpr_read_b32 v199, a123
  v_fma_f32 v192, v199, 0, v192
  v_accvgpr_read_b32 v196, a124
  v_fma_f32 v192, v196, 0, v192
  v_accvgpr_read_b32 v197, a125
  v_fma_f32 v192, v197, 0, v192
  v_accvgpr_read_b32 v198, a126
  v_fma_f32 v192, v198, 0, v192
  v_accvgpr_read_b32 v199, a127
  v_fma_f32 v192, v199, 0, v192
  s_mov_b32 s40, 0xd800000
  v_cmp_eq_f32 vcc, 0, v192
  v_cmp_lt_f32 s[84:85], s40, v28
  v_cmp_lt_f32 s[86:87], s40, v29
  v_cmp_lt_f32 s[88:89], s40, v30
  v_cmp_lt_f32 s[90:91], s40, v31
  s_nop 1
  s_and_b64 vcc, vcc, s[84:85]
  s_and_b64 vcc, vcc, s[86:87]
  s_and_b64 vcc, vcc, s[88:89]
  s_and_b64 vcc, vcc, s[90:91]
  s_cmp_eq_u64 vcc, -1
  s_cbranch_scc1 L_end
  s_waitcnt vmcnt(0) lgkmcnt(0)
  v_subrev_u32 v40, s31, v16
  v_subrev_u32 v41, s31, v17
  v_subrev_u32 v42, s31, v18
  v_subrev_u32 v43, s31, v19
  v_subrev_u32 v44, s31, v20
  v_subrev_u32 v45, s31, v21
  s_add_u32 s40, s82, 8192
  v_add_u32 v4, s40, v4
  v_add_u32 v5, s40, v5
  v_add_u32 v6, s40, v6
  v_add_u32 v7, s40, v7
  s_add_u32 m0, s82, 8192
  s_nop 0
  buffer_load_dwordx4 v16, s[12:15], s3 offen lds
  buffer_load_dwordx4 v17, s[12:15], s3 offen offset:1024 lds
  buffer_load_dwordx4 v18, s[12:15], s3 offen offset:2048 lds
  buffer_load_dwordx4 v19, s[12:15], s3 offen offset:3072 lds
  s_waitcnt vmcnt(0)
  ds_read_b128 v[64:67], v4 offset:0
  ds_read_b128 v[68:71], v5 offset:0
  ds_read_b128 v[72:75], v6 offset:0
  ds_read_b128 v[76:79], v7 offset:0
  s_waitcnt lgkmcnt(3)
  v_lshlrev_b32 v192, 16, v64
  v_and_b32 v193, 0xffff0000, v64
  v_mul_f32 v192, s36, v192
  v_mul_f32 v193, s36, v193
  v_cvt_pk_bf16_f32 v64, v192, v193
  v_accvgpr_write_b32 a128, v64
  v_lshlrev_b32 v194, 16, v65
  v_and_b32 v195, 0xffff0000, v65
  v_mul_f32 v194, s36, v194
  v_mul_f32 v195, s36, v195
  v_cvt_pk_bf16_f32 v65, v194, v195
  v_accvgpr_write_b32 a129, v65
  v_lshlrev_b32 v196, 16, v66
  v_and_b32 v197, 0xffff0000, v66
  v_mul_f32 v196, s36, v196
  v_mul_f32 v197, s36, v197
  v_cvt_pk_bf16_f32 v66, v196, v197
  v_accvgpr_write_b32 a130, v66
  v_lshlrev_b32 v198, 16, v67
  v_and_b32 v199, 0xffff0000, v67
  v_mul_f32 v198, s36, v198
  v_mul_f32 v199, s36, v199
  v_cvt_pk_bf16_f32 v67, v198, v199
  v_accvgpr_write_b32 a131, v67
  s_waitcnt lgkmcnt(2)
  v_lshlrev_b32 v192, 16, v68
  v_and_b32 v193, 0xffff0000, v68
  v_mul_f32 v192, s36, v192
  v_mul_f32 v193, s36, v193
  v_cvt_pk_bf16_f32 v68, v192, v193
  v_accvgpr_write_b32 a132, v68
  v_lshlrev_b32 v194, 16, v69
  v_and_b32 v195, 0xffff0000, v69
  v_mul_f32 v194, s36, v194
  v_mul_f32 v195, s36, v195
  v_cvt_pk_bf16_f32 v69, v194, v195
  v_accvgpr_write_b32 a133, v69
  v_lshlrev_b32 v196, 16, v70
  v_and_b32 v197, 0xffff0000, v70
  v_mul_f32 v196, s36, v196
  v_mul_f32 v197, s36, v197
  v_cvt_pk_bf16_f32 v70, v196, v197
  v_accvgpr_write_b32 a134, v70
  v_lshlrev_b32 v198, 16, v71
  v_and_b32 v199, 0xffff0000, v71
  v_mul_f32 v198, s36, v198
  v_mul_f32 v199, s36, v199
  v_cvt_pk_bf16_f32 v71, v198, v199
  v_accvgpr_write_b32 a135, v71
  s_waitcnt lgkmcnt(0)
  v_lshlrev_b32 v192, 16, v72
  v_and_b32 v193, 0xffff0000, v72
  v_mul_f32 v192, s36, v192
  v_mul_f32 v193, s36, v193
  v_cvt_pk_bf16_f32 v72, v192, v193
  v_accvgpr_write_b32 a136, v72
  v_lshlrev_b32 v194, 16, v73
  v_and_b32 v195, 0xffff0000, v73
  v_mul_f32 v194, s36, v194
  v_mul_f32 v195, s36, v195
  v_cvt_pk_bf16_f32 v73, v194, v195
  v_accvgpr_write_b32 a137, v73
  v_lshlrev_b32 v196, 16, v74
  v_and_b32 v197, 0xffff0000, v74
  v_mul_f32 v196, s36, v196
  v_mul_f32 v197, s36, v197
  v_cvt_pk_bf16_f32 v74, v196, v197
  v_accvgpr_write_b32 a138, v74
  v_lshlrev_b32 v198, 16, v75
  v_and_b32 v199, 0xffff0000, v75
  v_mul_f32 v198, s36, v198
  v_mul_f32 v199, s36, v199
  v_cvt_pk_bf16_f32 v75, v198, v199
  v_accvgpr_write_b32 a139, v75
  v_lshlrev_b32 v192, 16, v76
  v_and_b32 v193, 0xffff0000, v76
  v_mul_f32 v192, s36, v192
  v_mul_f32 v193, s36, v193
  v_cvt_pk_bf16_f32 v76, v192, v193
  v_accvgpr_write_b32 a140, v76
  v_lshlrev_b32 v194, 16, v77
  v_and_b32 v195, 0xffff0000, v77
  v_mul_f32 v194, s36, v194
  v_mul_f32 v195, s36, v195
  v_cvt_pk_bf16_f32 v77, v194, v195
  v_accvgpr_write_b32 a141, v77
  v_lshlrev_b32 v196, 16, v78
  v_and_b32 v197, 0xffff0000, v78
  v_mul_f32 v196, s36, v196
  v_mul_f32 v197, s36, v197
  v_cvt_pk_bf16_f32 v78, v196, v197
  v_accvgpr_write_b32 a142, v78
  v_lshlrev_b32 v198, 16, v79
  v_and_b32 v199, 0xffff0000, v79
  v_mul_f32 v198, s36, v198
  v_mul_f32 v199, s36, v199
  v_cvt_pk_bf16_f32 v79, v198, v199
  v_accvgpr_write_b32 a143, v79
  s_add_u32 m0, s82, 8192
  s_nop 0
  buffer_load_dwordx4 v16, s[12:15], s33 offen lds
  buffer_load_dwordx4 v17, s[12:15], s33 offen offset:1024 lds
  buffer_load_dwordx4 v18, s[12:15], s33 offen offset:2048 lds
  buffer_load_dwordx4 v19, s[12:15], s33 offen offset:3072 lds
  s_waitcnt vmcnt(0)
  ds_read_b128 v[64:67], v4 offset:0
  ds_read_b128 v[68:71], v5 offset:0
  ds_read_b128 v[72:75], v6 offset:0
  ds_read_b128 v[76:79], v7 offset:0
  s_waitcnt lgkmcnt(3)
  v_lshlrev_b32 v192, 16, v64
  v_and_b32 v193, 0xffff0000, v64
  v_mul_f32 v192, s36, v192
  v_mul_f32 v193, s36, v193
  v_cvt_pk_bf16_f32 v64, v192, v193
  v_accvgpr_write_b32 a144, v64
  v_lshlrev_b32 v194, 16, v65
  v_and_b32 v195, 0xffff0000, v65
  v_mul_f32 v194, s36, v194
  v_mul_f32 v195, s36, v195
  v_cvt_pk_bf16_f32 v65, v194, v195
  v_accvgpr_write_b32 a145, v65
  v_lshlrev_b32 v196, 16, v66
  v_and_b32 v197, 0xffff0000, v66
  v_mul_f32 v196, s36, v196
  v_mul_f32 v197, s36, v197
  v_cvt_pk_bf16_f32 v66, v196, v197
  v_accvgpr_write_b32 a146, v66
  v_lshlrev_b32 v198, 16, v67
  v_and_b32 v199, 0xffff0000, v67
  v_mul_f32 v198, s36, v198
  v_mul_f32 v199, s36, v199
  v_cvt_pk_bf16_f32 v67, v198, v199
  v_accvgpr_write_b32 a147, v67
  s_waitcnt lgkmcnt(2)
  v_lshlrev_b32 v192, 16, v68
  v_and_b32 v193, 0xffff0000, v68
  v_mul_f32 v192, s36, v192
  v_mul_f32 v193, s36, v193
  v_cvt_pk_bf16_f32 v68, v192, v193
  v_accvgpr_write_b32 a148, v68
  v_lshlrev_b32 v194, 16, v69
  v_and_b32 v195, 0xffff0000, v69
  v_mul_f32 v194, s36, v194
  v_mul_f32 v195, s36, v195
  v_cvt_pk_bf16_f32 v69, v194, v195
  v_accvgpr_write_b32 a149, v69
  v_lshlrev_b32 v196, 16, v70
  v_and_b32 v197, 0xffff0000, v70
  v_mul_f32 v196, s36, v196
  v_mul_f32 v197, s36, v197
  v_cvt_pk_bf16_f32 v70, v196, v197
  v_accvgpr_write_b32 a150, v70
  v_lshlrev_b32 v198, 16, v71
  v_and_b32 v199, 0xffff0000, v71
  v_mul_f32 v198, s36, v198
  v_mul_f32 v199, s36, v199
  v_cvt_pk_bf16_f32 v71, v198, v199
  v_accvgpr_write_b32 a151, v71
  s_waitcnt lgkmcnt(0)
  v_lshlrev_b32 v192, 16, v72
  v_and_b32 v193, 0xffff0000, v72
  v_mul_f32 v192, s36, v192
  v_mul_f32 v193, s36, v193
  v_cvt_pk_bf16_f32 v72, v192, v193
  v_accvgpr_write_b32 a152, v72
  v_lshlrev_b32 v194, 16, v73
  v_and_b32 v195, 0xffff0000, v73
  v_mul_f32 v194, s36, v194
  v_mul_f32 v195, s36, v195
  v_cvt_pk_bf16_f32 v73, v194, v195
  v_accvgpr_write_b32 a153, v73
  v_lshlrev_b32 v196, 16, v74
  v_and_b32 v197, 0xffff0000, v74
  v_mul_f32 v196, s36, v196
  v_mul_f32 v197, s36, v197
  v_cvt_pk_bf16_f32 v74, v196, v197
  v_accvgpr_write_b32 a154, v74
  v_lshlrev_b32 v198, 16, v75
  v_and_b32 v199, 0xffff0000, v75
  v_mul_f32 v198, s36, v198
  v_mul_f32 v199, s36, v199
  v_cvt_pk_bf16_f32 v75, v198, v199
  v_accvgpr_write_b32 a155, v75
  v_lshlrev_b32 v192, 16, v76
  v_and_b32 v193, 0xffff0000, v76
  v_mul_f32 v192, s36, v192
  v_mul_f32 v193, s36, v193
  v_cvt_pk_bf16_f32 v76, v192, v193
  v_accvgpr_write_b32 a156, v76
  v_lshlrev_b32 v194, 16, v77
  v_and_b32 v195, 0xffff0000, v77
  v_mul_f32 v194, s36, v194
  v_mul_f32 v195, s36, v195
  v_cvt_pk_bf16_f32 v77, v194, v195
  v_accvgpr_write_b32 a157, v77
  v_lshlrev_b32 v196, 16, v78
  v_and_b32 v197, 0xffff0000, v78
  v_mul_f32 v196, s36, v196
  v_mul_f32 v197, s36, v197
  v_cvt_pk_bf16_f32 v78, v196, v197
  v_accvgpr_write_b32 a158, v78
  v_lshlrev_b32 v198, 16, v79
  v_and_b32 v199, 0xffff0000, v79
  v_mul_f32 v198, s36, v198
  v_mul_f32 v199, s36, v199
  v_cvt_pk_bf16_f32 v79, v198, v199
  v_accvgpr_write_b32 a159, v79
  s_add_u32 m0, s82, 8192
  s_nop 0
  buffer_load_dwordx4 v16, s[12:15], s34 offen lds
  buffer_load_dwordx4 v17, s[12:15], s34 offen offset:1024 lds
  buffer_load_dwordx4 v18, s[12:15], s34 offen offset:2048 lds
  buffer_load_dwordx4 v19, s[12:15], s34 offen offset:3072 lds
  s_waitcnt vmcnt(0)
  ds_read_b128 v[64:67], v4 offset:0
  ds_read_b128 v[68:71], v5 offset:0
  ds_read_b128 v[72:75], v6 offset:0
  ds_read_b128 v[76:79], v7 offset:0
  s_waitcnt lgkmcnt(3)
  v_lshlrev_b32 v192, 16, v64
  v_and_b32 v193, 0xffff0000, v64
  v_mul_f32 v192, s36, v192
  v_mul_f32 v193, s36, v193
  v_cvt_pk_bf16_f32 v64, v192, v193
  v_accvgpr_write_b32 a160, v64
  v_lshlrev_b32 v194, 16, v65
  v_and_b32 v195, 0xffff0000, v65
  v_mul_f32 v194, s36, v194
  v_mul_f32 v195, s36, v195
  v_cvt_pk_bf16_f32 v65, v194, v195
  v_accvgpr_write_b32 a161, v65
  v_lshlrev_b32 v196, 16, v66
  v_and_b32 v197, 0xffff0000, v66
  v_mul_f32 v196, s36, v196
  v_mul_f32 v197, s36, v197
  v_cvt_pk_bf16_f32 v66, v196, v197
  v_accvgpr_write_b32 a162, v66
  v_lshlrev_b32 v198, 16, v67
  v_and_b32 v199, 0xffff0000, v67
  v_mul_f32 v198, s36, v198
  v_mul_f32 v199, s36, v199
  v_cvt_pk_bf16_f32 v67, v198, v199
  v_accvgpr_write_b32 a163, v67
  s_waitcnt lgkmcnt(2)
  v_lshlrev_b32 v192, 16, v68
  v_and_b32 v193, 0xffff0000, v68
  v_mul_f32 v192, s36, v192
  v_mul_f32 v193, s36, v193
  v_cvt_pk_bf16_f32 v68, v192, v193
  v_accvgpr_write_b32 a164, v68
  v_lshlrev_b32 v194, 16, v69
  v_and_b32 v195, 0xffff0000, v69
  v_mul_f32 v194, s36, v194
  v_mul_f32 v195, s36, v195
  v_cvt_pk_bf16_f32 v69, v194, v195
  v_accvgpr_write_b32 a165, v69
  v_lshlrev_b32 v196, 16, v70
  v_and_b32 v197, 0xffff0000, v70
  v_mul_f32 v196, s36, v196
  v_mul_f32 v197, s36, v197
  v_cvt_pk_bf16_f32 v70, v196, v197
  v_accvgpr_write_b32 a166, v70
  v_lshlrev_b32 v198, 16, v71
  v_and_b32 v199, 0xffff0000, v71
  v_mul_f32 v198, s36, v198
  v_mul_f32 v199, s36, v199
  v_cvt_pk_bf16_f32 v71, v198, v199
  v_accvgpr_write_b32 a167, v71
  s_waitcnt lgkmcnt(0)
  v_lshlrev_b32 v192, 16, v72
  v_and_b32 v193, 0xffff0000, v72
  v_mul_f32 v192, s36, v192
  v_mul_f32 v193, s36, v193
  v_cvt_pk_bf16_f32 v72, v192, v193
  v_accvgpr_write_b32 a168, v72
  v_lshlrev_b32 v194, 16, v73
  v_and_b32 v195, 0xffff0000, v73
  v_mul_f32 v194, s36, v194
  v_mul_f32 v195, s36, v195
  v_cvt_pk_bf16_f32 v73, v194, v195
  v_accvgpr_write_b32 a169, v73
  v_lshlrev_b32 v196, 16, v74
  v_and_b32 v197, 0xffff0000, v74
  v_mul_f32 v196, s36, v196
  v_mul_f32 v197, s36, v197
  v_cvt_pk_bf16_f32 v74, v196, v197
  v_accvgpr_write_b32 a170, v74
  v_lshlrev_b32 v198, 16, v75
  v_and_b32 v199, 0xffff0000, v75
  v_mul_f32 v198, s36, v198
  v_mul_f32 v199, s36, v199
  v_cvt_pk_bf16_f32 v75, v198, v199
  v_accvgpr_write_b32 a171, v75
  v_lshlrev_b32 v192, 16, v76
  v_and_b32 v193, 0xffff0000, v76
  v_mul_f32 v192, s36, v192
  v_mul_f32 v193, s36, v193
  v_cvt_pk_bf16_f32 v76, v192, v193
  v_accvgpr_write_b32 a172, v76
  v_lshlrev_b32 v194, 16, v77
  v_and_b32 v195, 0xffff0000, v77
  v_mul_f32 v194, s36, v194
  v_mul_f32 v195, s36, v195
  v_cvt_pk_bf16_f32 v77, v194, v195
  v_accvgpr_write_b32 a173, v77
  v_lshlrev_b32 v196, 16, v78
  v_and_b32 v197, 0xffff0000, v78
  v_mul_f32 v196, s36, v196
  v_mul_f32 v197, s36, v197
  v_cvt_pk_bf16_f32 v78, v196, v197
  v_accvgpr_write_b32 a174, v78
  v_lshlrev_b32 v198, 16, v79
  v_and_b32 v199, 0xffff0000, v79
  v_mul_f32 v198, s36, v198
  v_mul_f32 v199, s36, v199
  v_cvt_pk_bf16_f32 v79, v198, v199
  v_accvgpr_write_b32 a175, v79
  s_add_u32 m0, s82, 8192
  s_nop 0
  buffer_load_dwordx4 v16, s[12:15], s35 offen lds
  buffer_load_dwordx4 v17, s[12:15], s35 offen offset:1024 lds
  buffer_load_dwordx4 v18, s[12:15], s35 offen offset:2048 lds
  buffer_load_dwordx4 v19, s[12:15], s35 offen offset:3072 lds
  s_waitcnt vmcnt(0)
  ds_read_b128 v[64:67], v4 offset:0
  ds_read_b128 v[68:71], v5 offset:0
  ds_read_b128 v[72:75], v6 offset:0
  ds_read_b128 v[76:79], v7 offset:0
  s_waitcnt lgkmcnt(3)
  v_lshlrev_b32 v192, 16, v64
  v_and_b32 v193, 0xffff0000, v64
  v_mul_f32 v192, s36, v192
  v_mul_f32 v193, s36, v193
  v_cvt_pk_bf16_f32 v64, v192, v193
  v_accvgpr_write_b32 a176, v64
  v_lshlrev_b32 v194, 16, v65
  v_and_b32 v195, 0xffff0000, v65
  v_mul_f32 v194, s36, v194
  v_mul_f32 v195, s36, v195
  v_cvt_pk_bf16_f32 v65, v194, v195
  v_accvgpr_write_b32 a177, v65
  v_lshlrev_b32 v196, 16, v66
  v_and_b32 v197, 0xffff0000, v66
  v_mul_f32 v196, s36, v196
  v_mul_f32 v197, s36, v197
  v_cvt_pk_bf16_f32 v66, v196, v197
  v_accvgpr_write_b32 a178, v66
  v_lshlrev_b32 v198, 16, v67
  v_and_b32 v199, 0xffff0000, v67
  v_mul_f32 v198, s36, v198
  v_mul_f32 v199, s36, v199
  v_cvt_pk_bf16_f32 v67, v198, v199
  v_accvgpr_write_b32 a179, v67
  s_waitcnt lgkmcnt(2)
  v_lshlrev_b32 v192, 16, v68
  v_and_b32 v193, 0xffff0000, v68
  v_mul_f32 v192, s36, v192
  v_mul_f32 v193, s36, v193
  v_cvt_pk_bf16_f32 v68, v192, v193
  v_accvgpr_write_b32 a180, v68
  v_lshlrev_b32 v194, 16, v69
  v_and_b32 v195, 0xffff0000, v69
  v_mul_f32 v194, s36, v194
  v_mul_f32 v195, s36, v195
  v_cvt_pk_bf16_f32 v69, v194, v195
  v_accvgpr_write_b32 a181, v69
  v_lshlrev_b32 v196, 16, v70
  v_and_b32 v197, 0xffff0000, v70
  v_mul_f32 v196, s36, v196
  v_mul_f32 v197, s36, v197
  v_cvt_pk_bf16_f32 v70, v196, v197
  v_accvgpr_write_b32 a182, v70
  v_lshlrev_b32 v198, 16, v71
  v_and_b32 v199, 0xffff0000, v71
  v_mul_f32 v198, s36, v198
  v_mul_f32 v199, s36, v199
  v_cvt_pk_bf16_f32 v71, v198, v199
  v_accvgpr_write_b32 a183, v71
  s_waitcnt lgkmcnt(0)
  v_lshlrev_b32 v192, 16, v72
  v_and_b32 v193, 0xffff0000, v72
  v_mul_f32 v192, s36, v192
  v_mul_f32 v193, s36, v193
  v_cvt_pk_bf16_f32 v72, v192, v193
  v_accvgpr_write_b32 a184, v72
  v_lshlrev_b32 v194, 16, v73
  v_and_b32 v195, 0xffff0000, v73
  v_mul_f32 v194, s36, v194
  v_mul_f32 v195, s36, v195
  v_cvt_pk_bf16_f32 v73, v194, v195
  v_accvgpr_write_b32 a185, v73
  v_lshlrev_b32 v196, 16, v74
  v_and_b32 v197, 0xffff0000, v74
  v_mul_f32 v196, s36, v196
  v_mul_f32 v197, s36, v197
  v_cvt_pk_bf16_f32 v74, v196, v197
  v_accvgpr_write_b32 a186, v74
  v_lshlrev_b32 v198, 16, v75
  v_and_b32 v199, 0xffff0000, v75
  v_mul_f32 v198, s36, v198
  v_mul_f32 v199, s36, v199
  v_cvt_pk_bf16_f32 v75, v198, v199
  v_accvgpr_write_b32 a187, v75
  v_lshlrev_b32 v192, 16, v76
  v_and_b32 v193, 0xffff0000, v76
  v_mul_f32 v192, s36, v192
  v_mul_f32 v193, s36, v193
  v_cvt_pk_bf16_f32 v76, v192, v193
  v_accvgpr_write_b32 a188, v76
  v_lshlrev_b32 v194, 16, v77
  v_and_b32 v195, 0xffff0000, v77
  v_mul_f32 v194, s36, v194
  v_mul_f32 v195, s36, v195
  v_cvt_pk_bf16_f32 v77, v194, v195
  v_accvgpr_write_b32 a189, v77
  v_lshlrev_b32 v196, 16, v78
  v_and_b32 v197, 0xffff0000, v78
  v_mul_f32 v196, s36, v196
  v_mul_f32 v197, s36, v197
  v_cvt_pk_bf16_f32 v78, v196, v197
  v_accvgpr_write_b32 a190, v78
  v_lshlrev_b32 v198, 16, v79
  v_and_b32 v199, 0xffff0000, v79
  v_mul_f32 v198, s36, v198
  v_mul_f32 v199, s36, v199
  v_cvt_pk_bf16_f32 v79, v198, v199
  v_accvgpr_write_b32 a191, v79
  s_sub_u32 s40, s82, 65536
  v_add_u32 v8, s40, v8
  v_add_u32 v9, s40, v9
  v_add_u32 v10, s40, v10
  v_add_u32 v11, s40, v11
  v_add_u32 v12, s40, v12
  v_add_u32 v13, s40, v13
  v_add_u32 v14, s40, v14
  v_add_u32 v15, s40, v15
  v_mov_b32 v32, 0xff800000
  v_mov_b32 v28, 0
  v_mov_b32 v33, 0xff800000
  v_mov_b32 v29, 0
  v_mov_b32 v34, 0xff800000
  v_mov_b32 v30, 0
  v_mov_b32 v35, 0xff800000
  v_mov_b32 v31, 0
  v_accvgpr_write_b32 a0, 0
  v_accvgpr_write_b32 a1, 0
  v_accvgpr_write_b32 a2, 0
  v_accvgpr_write_b32 a3, 0
  v_accvgpr_write_b32 a4, 0
  v_accvgpr_write_b32 a5, 0
  v_accvgpr_write_b32 a6, 0
  v_accvgpr_write_b32 a7, 0
  v_accvgpr_write_b32 a8, 0
  v_accvgpr_write_b32 a9, 0
  v_accvgpr_write_b32 a10, 0
  v_accvgpr_write_b32 a11, 0
  v_accvgpr_write_b32 a12, 0
  v_accvgpr_write_b32 a13, 0
  v_accvgpr_write_b32 a14, 0
  v_accvgpr_write_b32 a15, 0
  v_accvgpr_write_b32 a16, 0
  v_accvgpr_write_b32 a17, 0
  v_accvgpr_write_b32 a18, 0
  v_accvgpr_write_b32 a19, 0
  v_accvgpr_write_b32 a20, 0
  v_accvgpr_write_b32 a21, 0
  v_accvgpr_write_b32 a22, 0
  v_accvgpr_write_b32 a23, 0
  v_accvgpr_write_b32 a24, 0
  v_accvgpr_write_b32 a25, 0
  v_accvgpr_write_b32 a26, 0
  v_accvgpr_write_b32 a27, 0
  v_accvgpr_write_b32 a28, 0
  v_accvgpr_write_b32 a29, 0
  v_accvgpr_write_b32 a30, 0
  v_accvgpr_write_b32 a31, 0
  v_accvgpr_write_b32 a32, 0
  v_accvgpr_write_b32 a33, 0
  v_accvgpr_write_b32 a34, 0
  v_accvgpr_write_b32 a35, 0
  v_accvgpr_write_b32 a36, 0
  v_accvgpr_write_b32 a37, 0
  v_accvgpr_write_b32 a38, 0
  v_accvgpr_write_b32 a39, 0
  v_accvgpr_write_b32 a40, 0
  v_accvgpr_write_b32 a41, 0
  v_accvgpr_write_b32 a42, 0
  v_accvgpr_write_b32 a43, 0
  v_accvgpr_write_b32 a44, 0
  v_accvgpr_write_b32 a45, 0
  v_accvgpr_write_b32 a46, 0
  v_accvgpr_write_b32 a47, 0
  v_accvgpr_write_b32 a48, 0
  v_accvgpr_write_b32 a49, 0
  v_accvgpr_write_b32 a50, 0
  v_accvgpr_write_b32 a51, 0
  v_accvgpr_write_b32 a52, 0
  v_accvgpr_write_b32 a53, 0
  v_accvgpr_write_b32 a54, 0
  v_accvgpr_write_b32 a55, 0
  v_accvgpr_write_b32 a56, 0
  v_accvgpr_write_b32 a57, 0
  v_accvgpr_write_b32 a58, 0
  v_accvgpr_write_b32 a59, 0
  v_accvgpr_write_b32 a60, 0
  v_accvgpr_write_b32 a61, 0
  v_accvgpr_write_b32 a62, 0
  v_accvgpr_write_b32 a63, 0
  v_accvgpr_write_b32 a64, 0
  v_accvgpr_write_b32 a65, 0
  v_accvgpr_write_b32 a66, 0
  v_accvgpr_write_b32 a67, 0
  v_accvgpr_write_b32 a68, 0
  v_accvgpr_write_b32 a69, 0
  v_accvgpr_write_b32 a70, 0
  v_accvgpr_write_b32 a71, 0
  v_accvgpr_write_b32 a72, 0
  v_accvgpr_write_b32 a73, 0
  v_accvgpr_write_b32 a74, 0
  v_accvgpr_write_b32 a75, 0
  v_accvgpr_write_b32 a76, 0
  v_accvgpr_write_b32 a77, 0
  v_accvgpr_write_b32 a78, 0
  v_accvgpr_write_b32 a79, 0
  v_accvgpr_write_b32 a80, 0
  v_accvgpr_write_b32 a81, 0
  v_accvgpr_write_b32 a82, 0
  v_accvgpr_write_b32 a83, 0
  v_accvgpr_write_b32 a84, 0
  v_accvgpr_write_b32 a85, 0
  v_accvgpr_write_b32 a86, 0
  v_accvgpr_write_b32 a87, 0
  v_accvgpr_write_b32 a88, 0
  v_accvgpr_write_b32 a89, 0
  v_accvgpr_write_b32 a90, 0
  v_accvgpr_write_b32 a91, 0
  v_accvgpr_write_b32 a92, 0
  v_accvgpr_write_b32 a93, 0
  v_accvgpr_write_b32 a94, 0
  v_accvgpr_write_b32 a95, 0
  v_accvgpr_write_b32 a96, 0
  v_accvgpr_write_b32 a97, 0
  v_accvgpr_write_b32 a98, 0
  v_accvgpr_write_b32 a99, 0
  v_accvgpr_write_b32 a100, 0
  v_accvgpr_write_b32 a101, 0
  v_accvgpr_write_b32 a102, 0
  v_accvgpr_write_b32 a103, 0
  v_accvgpr_write_b32 a104, 0
  v_accvgpr_write_b32 a105, 0
  v_accvgpr_write_b32 a106, 0
  v_accvgpr_write_b32 a107, 0
  v_accvgpr_write_b32 a108, 0
  v_accvgpr_write_b32 a109, 0
  v_accvgpr_write_b32 a110, 0
  v_accvgpr_write_b32 a111, 0
  v_accvgpr_write_b32 a112, 0
  v_accvgpr_write_b32 a113, 0
  v_accvgpr_write_b32 a114, 0
  v_accvgpr_write_b32 a115, 0
  v_accvgpr_write_b32 a116, 0
  v_accvgpr_write_b32 a117, 0
  v_accvgpr_write_b32 a118, 0
  v_accvgpr_write_b32 a119, 0
  v_accvgpr_write_b32 a120, 0
  v_accvgpr_write_b32 a121, 0
  v_accvgpr_write_b32 a122, 0
  v_accvgpr_write_b32 a123, 0
  v_accvgpr_write_b32 a124, 0
  v_accvgpr_write_b32 a125, 0
  v_accvgpr_write_b32 a126, 0
  v_accvgpr_write_b32 a127, 0
  s_mov_b32 s29, 0
  L_slow_loop:
  s_add_u32 s39, s29, 4096
  s_add_u32 m0, s82, 8192
  s_nop 0
  buffer_load_dwordx4 v40, s[16:19], s29 offen lds
  buffer_load_dwordx4 v41, s[16:19], s29 offen offset:1024 lds
  buffer_load_dwordx4 v42, s[16:19], s29 offen offset:2048 lds
  buffer_load_dwordx4 v43, s[16:19], s29 offen offset:3072 lds
  s_add_u32 m0, s82, 0
  s_nop 0
  buffer_load_dwordx4 v44, s[20:23], s29 offen lds
  buffer_load_dwordx4 v45, s[20:23], s29 offen offset:1024 lds
  buffer_load_dwordx4 v44, s[20:23], s29 offen offset:2048 lds
  buffer_load_dwordx4 v45, s[20:23], s29 offen offset:3072 lds
  s_add_u32 m0, s82, 12288
  s_nop 0
  buffer_load_dwordx4 v40, s[16:19], s39 offen lds
  buffer_load_dwordx4 v41, s[16:19], s39 offen offset:1024 lds
  buffer_load_dwordx4 v42, s[16:19], s39 offen offset:2048 lds
  buffer_load_dwordx4 v43, s[16:19], s39 offen offset:3072 lds
  s_add_u32 m0, s82, 4096
  s_nop 0
  buffer_load_dwordx4 v44, s[20:23], s39 offen lds
  buffer_load_dwordx4 v45, s[20:23], s39 offen offset:1024 lds
  buffer_load_dwordx4 v44, s[20:23], s39 offen offset:2048 lds
  buffer_load_dwordx4 v45, s[20:23], s39 offen offset:3072 lds
  s_waitcnt vmcnt(0)
  ds_read_b128 a[192:195], v4 offset:0
  ds_read_b128 a[196:199], v5 offset:0
  ds_read_b128 a[200:203], v6 offset:0
  ds_read_b128 a[204:207], v7 offset:0
  ds_read_b128 a[208:211], v4 offset:4096
  ds_read_b128 a[212:215], v5 offset:4096
  ds_read_b128 a[216:219], v6 offset:4096
  ds_read_b128 a[220:223], v7 offset:4096
  ds_read_b64_tr_b16 a[224:225], v8 offset:0
  ds_read_b64_tr_b16 a[226:227], v8 offset:4096
  ds_read_b64_tr_b16 a[228:229], v9 offset:0
  ds_read_b64_tr_b16 a[230:231], v9 offset:4096
  ds_read_b64_tr_b16 a[232:233], v10 offset:0
  ds_read_b64_tr_b16 a[234:235], v10 offset:4096
  ds_read_b64_tr_b16 a[236:237], v11 offset:0
  ds_read_b64_tr_b16 a[238:239], v11 offset:4096
  ds_read_b64_tr_b16 a[240:241], v12 offset:0
  ds_read_b64_tr_b16 a[242:243], v12 offset:4096
  ds_read_b64_tr_b16 a[244:245], v13 offset:0
  ds_read_b64_tr_b16 a[246:247], v13 offset:4096
  ds_read_b64_tr_b16 a[248:249], v14 offset:0
  ds_read_b64_tr_b16 a[250:251], v14 offset:4096
  ds_read_b64_tr_b16 a[252:253], v15 offset:0
  ds_read_b64_tr_b16 a[254:255], v15 offset:4096
  s_waitcnt lgkmcnt(15)
  v_mfma_f32_16x16x32_bf16 v[192:195], a[192:195], a[128:131], 0
  v_mfma_f32_16x16x32_bf16 v[192:195], a[196:199], a[132:135], v[192:195]
  v_mfma_f32_16x16x32_bf16 v[192:195], a[200:203], a[136:139], v[192:195]
  v_mfma_f32_16x16x32_bf16 v[192:195], a[204:207], a[140:143], v[192:195]
  v_mfma_f32_16x16x32_bf16 v[196:199], a[192:195], a[144:147], 0
  v_mfma_f32_16x16x32_bf16 v[196:199], a[196:199], a[148:151], v[196:199]
  v_mfma_f32_16x16x32_bf16 v[196:199], a[200:203], a[152:155], v[196:199]
  v_mfma_f32_16x16x32_bf16 v[196:199], a[204:207], a[156:159], v[196:199]
  v_mfma_f32_16x16x32_bf16 v[200:203], a[192:195], a[160:163], 0
  v_mfma_f32_16x16x32_bf16 v[200:203], a[196:199], a[164:167], v[200:203]
  v_mfma_f32_16x16x32_bf16 v[200:203], a[200:203], a[168:171], v[200:203]
  v_mfma_f32_16x16x32_bf16 v[200:203], a[204:207], a[172:175], v[200:203]
  v_mfma_f32_16x16x32_bf16 v[204:207], a[192:195], a[176:179], 0
  v_mfma_f32_16x16x32_bf16 v[204:207], a[196:199], a[180:183], v[204:207]
  v_mfma_f32_16x16x32_bf16 v[204:207], a[200:203], a[184:187], v[204:207]
  v_mfma_f32_16x16x32_bf16 v[204:207], a[204:207], a[188:191], v[204:207]
  v_mfma_f32_16x16x32_bf16 v[208:211], a[208:211], a[128:131], 0
  v_mfma_f32_16x16x32_bf16 v[208:211], a[212:215], a[132:135], v[208:211]
  v_mfma_f32_16x16x32_bf16 v[208:211], a[216:219], a[136:139], v[208:211]
  v_mfma_f32_16x16x32_bf16 v[208:211], a[220:223], a[140:143], v[208:211]
  v_mfma_f32_16x16x32_bf16 v[212:215], a[208:211], a[144:147], 0
  v_mfma_f32_16x16x32_bf16 v[212:215], a[212:215], a[148:151], v[212:215]
  v_mfma_f32_16x16x32_bf16 v[212:215], a[216:219], a[152:155], v[212:215]
  v_mfma_f32_16x16x32_bf16 v[212:215], a[220:223], a[156:159], v[212:215]
  v_mfma_f32_16x16x32_bf16 v[216:219], a[208:211], a[160:163], 0
  v_mfma_f32_16x16x32_bf16 v[216:219], a[212:215], a[164:167], v[216:219]
  v_mfma_f32_16x16x32_bf16 v[216:219], a[216:219], a[168:171], v[216:219]
  v_mfma_f32_16x16x32_bf16 v[216:219], a[220:223], a[172:175], v[216:219]
  v_mfma_f32_16x16x32_bf16 v[220:223], a[208:211], a[176:179], 0
  v_mfma_f32_16x16x32_bf16 v[220:223], a[212:215], a[180:183], v[220:223]
  v_mfma_f32_16x16x32_bf16 v[220:223], a[216:219], a[184:187], v[220:223]
  v_mfma_f32_16x16x32_bf16 v[220:223], a[220:223], a[188:191], v[220:223]
  v_max3_f32 v58, v192, v193, v194
  v_max3_f32 v59, v195, v208, v209
  v_max3_f32 v58, v58, v210, v211
  v_max_f32 v58, v58, v59
  v_mov_b32 v59, v58
  s_nop 1
  v_permlane32_swap_b32 v58, v59
  v_max_f32 v58, v58, v59
  v_mov_b32 v59, v58
  s_nop 1
  v_permlane16_swap_b32 v58, v59
  v_max_f32 v58, v58, v59
  v_max_f32 v58, v58, v32
  v_sub_f32 v36, v32, v58
  v_mov_b32 v32, v58
  v_exp_f32 v36, v36
  v_sub_f32 v192, v192, v58
  v_sub_f32 v193, v193, v58
  v_sub_f32 v194, v194, v58
  v_sub_f32 v195, v195, v58
  v_sub_f32 v208, v208, v58
  v_sub_f32 v209, v209, v58
  v_sub_f32 v210, v210, v58
  v_sub_f32 v211, v211, v58
  v_exp_f32 v192, v192
  v_exp_f32 v193, v193
  v_exp_f32 v194, v194
  v_exp_f32 v195, v195
  v_exp_f32 v208, v208
  v_exp_f32 v209, v209
  v_exp_f32 v210, v210
  v_exp_f32 v211, v211
  v_mul_f32 v28, v28, v36
  v_add_f32 v28, v28, v192
  v_add_f32 v28, v28, v193
  v_add_f32 v28, v28, v194
  v_add_f32 v28, v28, v195
  v_add_f32 v28, v28, v208
  v_add_f32 v28, v28, v209
  v_add_f32 v28, v28, v210
  v_add_f32 v28, v28, v211
  v_cvt_pk_bf16_f32 v64, v192, v193
  v_cvt_pk_bf16_f32 v65, v194, v195
  v_cvt_pk_bf16_f32 v66, v208, v209
  v_cvt_pk_bf16_f32 v67, v210, v211
  v_accvgpr_read_b32 v224, a0
  v_accvgpr_read_b32 v225, a1
  v_accvgpr_read_b32 v226, a2
  v_accvgpr_read_b32 v227, a3
  v_mul_f32 v224, v224, v36
  v_mul_f32 v225, v225, v36
  v_mul_f32 v226, v226, v36
  v_mul_f32 v227, v227, v36
  v_accvgpr_write_b32 a0, v224
  v_accvgpr_write_b32 a1, v225
  v_accvgpr_write_b32 a2, v226
  v_accvgpr_write_b32 a3, v227
  v_accvgpr_read_b32 v228, a4
  v_accvgpr_read_b32 v229, a5
  v_accvgpr_read_b32 v230, a6
  v_accvgpr_read_b32 v231, a7
  v_mul_f32 v228, v228, v36
  v_mul_f32 v229, v229, v36
  v_mul_f32 v230, v230, v36
  v_mul_f32 v231, v231, v36
  v_accvgpr_write_b32 a4, v228
  v_accvgpr_write_b32 a5, v229
  v_accvgpr_write_b32 a6, v230
  v_accvgpr_write_b32 a7, v231
  v_accvgpr_read_b32 v224, a8
  v_accvgpr_read_b32 v225, a9
  v_accvgpr_read_b32 v226, a10
  v_accvgpr_read_b32 v227, a11
  v_mul_f32 v224, v224, v36
  v_mul_f32 v225, v225, v36
  v_mul_f32 v226, v226, v36
  v_mul_f32 v227, v227, v36
  v_accvgpr_write_b32 a8, v224
  v_accvgpr_write_b32 a9, v225
  v_accvgpr_write_b32 a10, v226
  v_accvgpr_write_b32 a11, v227
  v_accvgpr_read_b32 v228, a12
  v_accvgpr_read_b32 v229, a13
  v_accvgpr_read_b32 v230, a14
  v_accvgpr_read_b32 v231, a15
  v_mul_f32 v228, v228, v36
  v_mul_f32 v229, v229, v36
  v_mul_f32 v230, v230, v36
  v_mul_f32 v231, v231, v36
  v_accvgpr_write_b32 a12, v228
  v_accvgpr_write_b32 a13, v229
  v_accvgpr_write_b32 a14, v230
  v_accvgpr_write_b32 a15, v231
  v_accvgpr_read_b32 v224, a16
  v_accvgpr_read_b32 v225, a17
  v_accvgpr_read_b32 v226, a18
  v_accvgpr_read_b32 v227, a19
  v_mul_f32 v224, v224, v36
  v_mul_f32 v225, v225, v36
  v_mul_f32 v226, v226, v36
  v_mul_f32 v227, v227, v36
  v_accvgpr_write_b32 a16, v224
  v_accvgpr_write_b32 a17, v225
  v_accvgpr_write_b32 a18, v226
  v_accvgpr_write_b32 a19, v227
  v_accvgpr_read_b32 v228, a20
  v_accvgpr_read_b32 v229, a21
  v_accvgpr_read_b32 v230, a22
  v_accvgpr_read_b32 v231, a23
  v_mul_f32 v228, v228, v36
  v_mul_f32 v229, v229, v36
  v_mul_f32 v230, v230, v36
  v_mul_f32 v231, v231, v36
  v_accvgpr_write_b32 a20, v228
  v_accvgpr_write_b32 a21, v229
  v_accvgpr_write_b32 a22, v230
  v_accvgpr_write_b32 a23, v231
  v_accvgpr_read_b32 v224, a24
  v_accvgpr_read_b32 v225, a25
  v_accvgpr_read_b32 v226, a26
  v_accvgpr_read_b32 v227, a27
  v_mul_f32 v224, v224, v36
  v_mul_f32 v225, v225, v36
  v_mul_f32 v226, v226, v36
  v_mul_f32 v227, v227, v36
  v_accvgpr_write_b32 a24, v224
  v_accvgpr_write_b32 a25, v225
  v_accvgpr_write_b32 a26, v226
  v_accvgpr_write_b32 a27, v227
  v_accvgpr_read_b32 v228, a28
  v_accvgpr_read_b32 v229, a29
  v_accvgpr_read_b32 v230, a30
  v_accvgpr_read_b32 v231, a31
  v_mul_f32 v228, v228, v36
  v_mul_f32 v229, v229, v36
  v_mul_f32 v230, v230, v36
  v_mul_f32 v231, v231, v36
  v_accvgpr_write_b32 a28, v228
  v_accvgpr_write_b32 a29, v229
  v_accvgpr_write_b32 a30, v230
  v_accvgpr_write_b32 a31, v231
  v_max3_f32 v58, v196, v197, v198
  v_max3_f32 v59, v199, v212, v213
  v_max3_f32 v58, v58, v214, v215
  v_max_f32 v58, v58, v59
  v_mov_b32 v59, v58
  s_nop 1
  v_permlane32_swap_b32 v58, v59
  v_max_f32 v58, v58, v59
  v_mov_b32 v59, v58
  s_nop 1
  v_permlane16_swap_b32 v58, v59
  v_max_f32 v58, v58, v59
  v_max_f32 v58, v58, v33
  v_sub_f32 v37, v33, v58
  v_mov_b32 v33, v58
  v_exp_f32 v37, v37
  v_sub_f32 v196, v196, v58
  v_sub_f32 v197, v197, v58
  v_sub_f32 v198, v198, v58
  v_sub_f32 v199, v199, v58
  v_sub_f32 v212, v212, v58
  v_sub_f32 v213, v213, v58
  v_sub_f32 v214, v214, v58
  v_sub_f32 v215, v215, v58
  v_exp_f32 v196, v196
  v_exp_f32 v197, v197
  v_exp_f32 v198, v198
  v_exp_f32 v199, v199
  v_exp_f32 v212, v212
  v_exp_f32 v213, v213
  v_exp_f32 v214, v214
  v_exp_f32 v215, v215
  v_mul_f32 v29, v29, v37
  v_add_f32 v29, v29, v196
  v_add_f32 v29, v29, v197
  v_add_f32 v29, v29, v198
  v_add_f32 v29, v29, v199
  v_add_f32 v29, v29, v212
  v_add_f32 v29, v29, v213
  v_add_f32 v29, v29, v214
  v_add_f32 v29, v29, v215
  v_cvt_pk_bf16_f32 v68, v196, v197
  v_cvt_pk_bf16_f32 v69, v198, v199
  v_cvt_pk_bf16_f32 v70, v212, v213
  v_cvt_pk_bf16_f32 v71, v214, v215
  v_accvgpr_read_b32 v224, a32
  v_accvgpr_read_b32 v225, a33
  v_accvgpr_read_b32 v226, a34
  v_accvgpr_read_b32 v227, a35
  v_mul_f32 v224, v224, v37
  v_mul_f32 v225, v225, v37
  v_mul_f32 v226, v226, v37
  v_mul_f32 v227, v227, v37
  v_accvgpr_write_b32 a32, v224
  v_accvgpr_write_b32 a33, v225
  v_accvgpr_write_b32 a34, v226
  v_accvgpr_write_b32 a35, v227
  v_accvgpr_read_b32 v228, a36
  v_accvgpr_read_b32 v229, a37
  v_accvgpr_read_b32 v230, a38
  v_accvgpr_read_b32 v231, a39
  v_mul_f32 v228, v228, v37
  v_mul_f32 v229, v229, v37
  v_mul_f32 v230, v230, v37
  v_mul_f32 v231, v231, v37
  v_accvgpr_write_b32 a36, v228
  v_accvgpr_write_b32 a37, v229
  v_accvgpr_write_b32 a38, v230
  v_accvgpr_write_b32 a39, v231
  v_accvgpr_read_b32 v224, a40
  v_accvgpr_read_b32 v225, a41
  v_accvgpr_read_b32 v226, a42
  v_accvgpr_read_b32 v227, a43
  v_mul_f32 v224, v224, v37
  v_mul_f32 v225, v225, v37
  v_mul_f32 v226, v226, v37
  v_mul_f32 v227, v227, v37
  v_accvgpr_write_b32 a40, v224
  v_accvgpr_write_b32 a41, v225
  v_accvgpr_write_b32 a42, v226
  v_accvgpr_write_b32 a43, v227
  v_accvgpr_read_b32 v228, a44
  v_accvgpr_read_b32 v229, a45
  v_accvgpr_read_b32 v230, a46
  v_accvgpr_read_b32 v231, a47
  v_mul_f32 v228, v228, v37
  v_mul_f32 v229, v229, v37
  v_mul_f32 v230, v230, v37
  v_mul_f32 v231, v231, v37
  v_accvgpr_write_b32 a44, v228
  v_accvgpr_write_b32 a45, v229
  v_accvgpr_write_b32 a46, v230
  v_accvgpr_write_b32 a47, v231
  v_accvgpr_read_b32 v224, a48
  v_accvgpr_read_b32 v225, a49
  v_accvgpr_read_b32 v226, a50
  v_accvgpr_read_b32 v227, a51
  v_mul_f32 v224, v224, v37
  v_mul_f32 v225, v225, v37
  v_mul_f32 v226, v226, v37
  v_mul_f32 v227, v227, v37
  v_accvgpr_write_b32 a48, v224
  v_accvgpr_write_b32 a49, v225
  v_accvgpr_write_b32 a50, v226
  v_accvgpr_write_b32 a51, v227
  v_accvgpr_read_b32 v228, a52
  v_accvgpr_read_b32 v229, a53
  v_accvgpr_read_b32 v230, a54
  v_accvgpr_read_b32 v231, a55
  v_mul_f32 v228, v228, v37
  v_mul_f32 v229, v229, v37
  v_mul_f32 v230, v230, v37
  v_mul_f32 v231, v231, v37
  v_accvgpr_write_b32 a52, v228
  v_accvgpr_write_b32 a53, v229
  v_accvgpr_write_b32 a54, v230
  v_accvgpr_write_b32 a55, v231
  v_accvgpr_read_b32 v224, a56
  v_accvgpr_read_b32 v225, a57
  v_accvgpr_read_b32 v226, a58
  v_accvgpr_read_b32 v227, a59
  v_mul_f32 v224, v224, v37
  v_mul_f32 v225, v225, v37
  v_mul_f32 v226, v226, v37
  v_mul_f32 v227, v227, v37
  v_accvgpr_write_b32 a56, v224
  v_accvgpr_write_b32 a57, v225
  v_accvgpr_write_b32 a58, v226
  v_accvgpr_write_b32 a59, v227
  v_accvgpr_read_b32 v228, a60
  v_accvgpr_read_b32 v229, a61
  v_accvgpr_read_b32 v230, a62
  v_accvgpr_read_b32 v231, a63
  v_mul_f32 v228, v228, v37
  v_mul_f32 v229, v229, v37
  v_mul_f32 v230, v230, v37
  v_mul_f32 v231, v231, v37
  v_accvgpr_write_b32 a60, v228
  v_accvgpr_write_b32 a61, v229
  v_accvgpr_write_b32 a62, v230
  v_accvgpr_write_b32 a63, v231
  v_max3_f32 v58, v200, v201, v202
  v_max3_f32 v59, v203, v216, v217
  v_max3_f32 v58, v58, v218, v219
  v_max_f32 v58, v58, v59
  v_mov_b32 v59, v58
  s_nop 1
  v_permlane32_swap_b32 v58, v59
  v_max_f32 v58, v58, v59
  v_mov_b32 v59, v58
  s_nop 1
  v_permlane16_swap_b32 v58, v59
  v_max_f32 v58, v58, v59
  v_max_f32 v58, v58, v34
  v_sub_f32 v38, v34, v58
  v_mov_b32 v34, v58
  v_exp_f32 v38, v38
  v_sub_f32 v200, v200, v58
  v_sub_f32 v201, v201, v58
  v_sub_f32 v202, v202, v58
  v_sub_f32 v203, v203, v58
  v_sub_f32 v216, v216, v58
  v_sub_f32 v217, v217, v58
  v_sub_f32 v218, v218, v58
  v_sub_f32 v219, v219, v58
  v_exp_f32 v200, v200
  v_exp_f32 v201, v201
  v_exp_f32 v202, v202
  v_exp_f32 v203, v203
  v_exp_f32 v216, v216
  v_exp_f32 v217, v217
  v_exp_f32 v218, v218
  v_exp_f32 v219, v219
  v_mul_f32 v30, v30, v38
  v_add_f32 v30, v30, v200
  v_add_f32 v30, v30, v201
  v_add_f32 v30, v30, v202
  v_add_f32 v30, v30, v203
  v_add_f32 v30, v30, v216
  v_add_f32 v30, v30, v217
  v_add_f32 v30, v30, v218
  v_add_f32 v30, v30, v219
  v_cvt_pk_bf16_f32 v72, v200, v201
  v_cvt_pk_bf16_f32 v73, v202, v203
  v_cvt_pk_bf16_f32 v74, v216, v217
  v_cvt_pk_bf16_f32 v75, v218, v219
  v_accvgpr_read_b32 v224, a64
  v_accvgpr_read_b32 v225, a65
  v_accvgpr_read_b32 v226, a66
  v_accvgpr_read_b32 v227, a67
  v_mul_f32 v224, v224, v38
  v_mul_f32 v225, v225, v38
  v_mul_f32 v226, v226, v38
  v_mul_f32 v227, v227, v38
  v_accvgpr_write_b32 a64, v224
  v_accvgpr_write_b32 a65, v225
  v_accvgpr_write_b32 a66, v226
  v_accvgpr_write_b32 a67, v227
  v_accvgpr_read_b32 v228, a68
  v_accvgpr_read_b32 v229, a69
  v_accvgpr_read_b32 v230, a70
  v_accvgpr_read_b32 v231, a71
  v_mul_f32 v228, v228, v38
  v_mul_f32 v229, v229, v38
  v_mul_f32 v230, v230, v38
  v_mul_f32 v231, v231, v38
  v_accvgpr_write_b32 a68, v228
  v_accvgpr_write_b32 a69, v229
  v_accvgpr_write_b32 a70, v230
  v_accvgpr_write_b32 a71, v231
  v_accvgpr_read_b32 v224, a72
  v_accvgpr_read_b32 v225, a73
  v_accvgpr_read_b32 v226, a74
  v_accvgpr_read_b32 v227, a75
  v_mul_f32 v224, v224, v38
  v_mul_f32 v225, v225, v38
  v_mul_f32 v226, v226, v38
  v_mul_f32 v227, v227, v38
  v_accvgpr_write_b32 a72, v224
  v_accvgpr_write_b32 a73, v225
  v_accvgpr_write_b32 a74, v226
  v_accvgpr_write_b32 a75, v227
  v_accvgpr_read_b32 v228, a76
  v_accvgpr_read_b32 v229, a77
  v_accvgpr_read_b32 v230, a78
  v_accvgpr_read_b32 v231, a79
  v_mul_f32 v228, v228, v38
  v_mul_f32 v229, v229, v38
  v_mul_f32 v230, v230, v38
  v_mul_f32 v231, v231, v38
  v_accvgpr_write_b32 a76, v228
  v_accvgpr_write_b32 a77, v229
  v_accvgpr_write_b32 a78, v230
  v_accvgpr_write_b32 a79, v231
  v_accvgpr_read_b32 v224, a80
  v_accvgpr_read_b32 v225, a81
  v_accvgpr_read_b32 v226, a82
  v_accvgpr_read_b32 v227, a83
  v_mul_f32 v224, v224, v38
  v_mul_f32 v225, v225, v38
  v_mul_f32 v226, v226, v38
  v_mul_f32 v227, v227, v38
  v_accvgpr_write_b32 a80, v224
  v_accvgpr_write_b32 a81, v225
  v_accvgpr_write_b32 a82, v226
  v_accvgpr_write_b32 a83, v227
  v_accvgpr_read_b32 v228, a84
  v_accvgpr_read_b32 v229, a85
  v_accvgpr_read_b32 v230, a86
  v_accvgpr_read_b32 v231, a87
  v_mul_f32 v228, v228, v38
  v_mul_f32 v229, v229, v38
  v_mul_f32 v230, v230, v38
  v_mul_f32 v231, v231, v38
  v_accvgpr_write_b32 a84, v228
  v_accvgpr_write_b32 a85, v229
  v_accvgpr_write_b32 a86, v230
  v_accvgpr_write_b32 a87, v231
  v_accvgpr_read_b32 v224, a88
  v_accvgpr_read_b32 v225, a89
  v_accvgpr_read_b32 v226, a90
  v_accvgpr_read_b32 v227, a91
  v_mul_f32 v224, v224, v38
  v_mul_f32 v225, v225, v38
  v_mul_f32 v226, v226, v38
  v_mul_f32 v227, v227, v38
  v_accvgpr_write_b32 a88, v224
  v_accvgpr_write_b32 a89, v225
  v_accvgpr_write_b32 a90, v226
  v_accvgpr_write_b32 a91, v227
  v_accvgpr_read_b32 v228, a92
  v_accvgpr_read_b32 v229, a93
  v_accvgpr_read_b32 v230, a94
  v_accvgpr_read_b32 v231, a95
  v_mul_f32 v228, v228, v38
  v_mul_f32 v229, v229, v38
  v_mul_f32 v230, v230, v38
  v_mul_f32 v231, v231, v38
  v_accvgpr_write_b32 a92, v228
  v_accvgpr_write_b32 a93, v229
  v_accvgpr_write_b32 a94, v230
  v_accvgpr_write_b32 a95, v231
  v_max3_f32 v58, v204, v205, v206
  v_max3_f32 v59, v207, v220, v221
  v_max3_f32 v58, v58, v222, v223
  v_max_f32 v58, v58, v59
  v_mov_b32 v59, v58
  s_nop 1
  v_permlane32_swap_b32 v58, v59
  v_max_f32 v58, v58, v59
  v_mov_b32 v59, v58
  s_nop 1
  v_permlane16_swap_b32 v58, v59
  v_max_f32 v58, v58, v59
  v_max_f32 v58, v58, v35
  v_sub_f32 v39, v35, v58
  v_mov_b32 v35, v58
  v_exp_f32 v39, v39
  v_sub_f32 v204, v204, v58
  v_sub_f32 v205, v205, v58
  v_sub_f32 v206, v206, v58
  v_sub_f32 v207, v207, v58
  v_sub_f32 v220, v220, v58
  v_sub_f32 v221, v221, v58
  v_sub_f32 v222, v222, v58
  v_sub_f32 v223, v223, v58
  v_exp_f32 v204, v204
  v_exp_f32 v205, v205
  v_exp_f32 v206, v206
  v_exp_f32 v207, v207
  v_exp_f32 v220, v220
  v_exp_f32 v221, v221
  v_exp_f32 v222, v222
  v_exp_f32 v223, v223
  v_mul_f32 v31, v31, v39
  v_add_f32 v31, v31, v204
  v_add_f32 v31, v31, v205
  v_add_f32 v31, v31, v206
  v_add_f32 v31, v31, v207
  v_add_f32 v31, v31, v220
  v_add_f32 v31, v31, v221
  v_add_f32 v31, v31, v222
  v_add_f32 v31, v31, v223
  v_cvt_pk_bf16_f32 v76, v204, v205
  v_cvt_pk_bf16_f32 v77, v206, v207
  v_cvt_pk_bf16_f32 v78, v220, v221
  v_cvt_pk_bf16_f32 v79, v222, v223
  v_accvgpr_read_b32 v224, a96
  v_accvgpr_read_b32 v225, a97
  v_accvgpr_read_b32 v226, a98
  v_accvgpr_read_b32 v227, a99
  v_mul_f32 v224, v224, v39
  v_mul_f32 v225, v225, v39
  v_mul_f32 v226, v226, v39
  v_mul_f32 v227, v227, v39
  v_accvgpr_write_b32 a96, v224
  v_accvgpr_write_b32 a97, v225
  v_accvgpr_write_b32 a98, v226
  v_accvgpr_write_b32 a99, v227
  v_accvgpr_read_b32 v228, a100
  v_accvgpr_read_b32 v229, a101
  v_accvgpr_read_b32 v230, a102
  v_accvgpr_read_b32 v231, a103
  v_mul_f32 v228, v228, v39
  v_mul_f32 v229, v229, v39
  v_mul_f32 v230, v230, v39
  v_mul_f32 v231, v231, v39
  v_accvgpr_write_b32 a100, v228
  v_accvgpr_write_b32 a101, v229
  v_accvgpr_write_b32 a102, v230
  v_accvgpr_write_b32 a103, v231
  v_accvgpr_read_b32 v224, a104
  v_accvgpr_read_b32 v225, a105
  v_accvgpr_read_b32 v226, a106
  v_accvgpr_read_b32 v227, a107
  v_mul_f32 v224, v224, v39
  v_mul_f32 v225, v225, v39
  v_mul_f32 v226, v226, v39
  v_mul_f32 v227, v227, v39
  v_accvgpr_write_b32 a104, v224
  v_accvgpr_write_b32 a105, v225
  v_accvgpr_write_b32 a106, v226
  v_accvgpr_write_b32 a107, v227
  v_accvgpr_read_b32 v228, a108
  v_accvgpr_read_b32 v229, a109
  v_accvgpr_read_b32 v230, a110
  v_accvgpr_read_b32 v231, a111
  v_mul_f32 v228, v228, v39
  v_mul_f32 v229, v229, v39
  v_mul_f32 v230, v230, v39
  v_mul_f32 v231, v231, v39
  v_accvgpr_write_b32 a108, v228
  v_accvgpr_write_b32 a109, v229
  v_accvgpr_write_b32 a110, v230
  v_accvgpr_write_b32 a111, v231
  v_accvgpr_read_b32 v224, a112
  v_accvgpr_read_b32 v225, a113
  v_accvgpr_read_b32 v226, a114
  v_accvgpr_read_b32 v227, a115
  v_mul_f32 v224, v224, v39
  v_mul_f32 v225, v225, v39
  v_mul_f32 v226, v226, v39
  v_mul_f32 v227, v227, v39
  v_accvgpr_write_b32 a112, v224
  v_accvgpr_write_b32 a113, v225
  v_accvgpr_write_b32 a114, v226
  v_accvgpr_write_b32 a115, v227
  v_accvgpr_read_b32 v228, a116
  v_accvgpr_read_b32 v229, a117
  v_accvgpr_read_b32 v230, a118
  v_accvgpr_read_b32 v231, a119
  v_mul_f32 v228, v228, v39
  v_mul_f32 v229, v229, v39
  v_mul_f32 v230, v230, v39
  v_mul_f32 v231, v231, v39
  v_accvgpr_write_b32 a116, v228
  v_accvgpr_write_b32 a117, v229
  v_accvgpr_write_b32 a118, v230
  v_accvgpr_write_b32 a119, v231
  v_accvgpr_read_b32 v224, a120
  v_accvgpr_read_b32 v225, a121
  v_accvgpr_read_b32 v226, a122
  v_accvgpr_read_b32 v227, a123
  v_mul_f32 v224, v224, v39
  v_mul_f32 v225, v225, v39
  v_mul_f32 v226, v226, v39
  v_mul_f32 v227, v227, v39
  v_accvgpr_write_b32 a120, v224
  v_accvgpr_write_b32 a121, v225
  v_accvgpr_write_b32 a122, v226
  v_accvgpr_write_b32 a123, v227
  v_accvgpr_read_b32 v228, a124
  v_accvgpr_read_b32 v229, a125
  v_accvgpr_read_b32 v230, a126
  v_accvgpr_read_b32 v231, a127
  v_mul_f32 v228, v228, v39
  v_mul_f32 v229, v229, v39
  v_mul_f32 v230, v230, v39
  v_mul_f32 v231, v231, v39
  v_accvgpr_write_b32 a124, v228
  v_accvgpr_write_b32 a125, v229
  v_accvgpr_write_b32 a126, v230
  v_accvgpr_write_b32 a127, v231
  s_waitcnt lgkmcnt(0)
  v_mfma_f32_16x16x32_bf16 a[0:3], a[224:227], v[64:67], a[0:3]
  v_mfma_f32_16x16x32_bf16 a[4:7], a[228:231], v[64:67], a[4:7]
  v_mfma_f32_16x16x32_bf16 a[8:11], a[232:235], v[64:67], a[8:11]
  v_mfma_f32_16x16x32_bf16 a[12:15], a[236:239], v[64:67], a[12:15]
  v_mfma_f32_16x16x32_bf16 a[16:19], a[240:243], v[64:67], a[16:19]
  v_mfma_f32_16x16x32_bf16 a[20:23], a[244:247], v[64:67], a[20:23]
  v_mfma_f32_16x16x32_bf16 a[24:27], a[248:251], v[64:67], a[24:27]
  v_mfma_f32_16x16x32_bf16 a[28:31], a[252:255], v[64:67], a[28:31]
  v_mfma_f32_16x16x32_bf16 a[32:35], a[224:227], v[68:71], a[32:35]
  v_mfma_f32_16x16x32_bf16 a[36:39], a[228:231], v[68:71], a[36:39]
  v_mfma_f32_16x16x32_bf16 a[40:43], a[232:235], v[68:71], a[40:43]
  v_mfma_f32_16x16x32_bf16 a[44:47], a[236:239], v[68:71], a[44:47]
  v_mfma_f32_16x16x32_bf16 a[48:51], a[240:243], v[68:71], a[48:51]
  v_mfma_f32_16x16x32_bf16 a[52:55], a[244:247], v[68:71], a[52:55]
  v_mfma_f32_16x16x32_bf16 a[56:59], a[248:251], v[68:71], a[56:59]
  v_mfma_f32_16x16x32_bf16 a[60:63], a[252:255], v[68:71], a[60:63]
  v_mfma_f32_16x16x32_bf16 a[64:67], a[224:227], v[72:75], a[64:67]
  v_mfma_f32_16x16x32_bf16 a[68:71], a[228:231], v[72:75], a[68:71]
  v_mfma_f32_16x16x32_bf16 a[72:75], a[232:235], v[72:75], a[72:75]
  v_mfma_f32_16x16x32_bf16 a[76:79], a[236:239], v[72:75], a[76:79]
  v_mfma_f32_16x16x32_bf16 a[80:83], a[240:243], v[72:75], a[80:83]
  v_mfma_f32_16x16x32_bf16 a[84:87], a[244:247], v[72:75], a[84:87]
  v_mfma_f32_16x16x32_bf16 a[88:91], a[248:251], v[72:75], a[88:91]
  v_mfma_f32_16x16x32_bf16 a[92:95], a[252:255], v[72:75], a[92:95]
  v_mfma_f32_16x16x32_bf16 a[96:99], a[224:227], v[76:79], a[96:99]
  v_mfma_f32_16x16x32_bf16 a[100:103], a[228:231], v[76:79], a[100:103]
  v_mfma_f32_16x16x32_bf16 a[104:107], a[232:235], v[76:79], a[104:107]
  v_mfma_f32_16x16x32_bf16 a[108:111], a[236:239], v[76:79], a[108:111]
  v_mfma_f32_16x16x32_bf16 a[112:115], a[240:243], v[76:79], a[112:115]
  v_mfma_f32_16x16x32_bf16 a[116:119], a[244:247], v[76:79], a[116:119]
  v_mfma_f32_16x16x32_bf16 a[120:123], a[248:251], v[76:79], a[120:123]
  v_mfma_f32_16x16x32_bf16 a[124:127], a[252:255], v[76:79], a[124:127]
  s_add_u32 s29, s29, 8192
  s_cmp_lt_u32 s29, 524288
  s_nop 15
  s_cbranch_scc1 L_slow_loop
  v_mov_b32 v58, v28
  v_mov_b32 v59, v29
  v_mov_b32 v60, v30
  v_mov_b32 v61, v31
  v_permlane32_swap_b32 v28, v58
  v_permlane32_swap_b32 v29, v59
  v_permlane32_swap_b32 v30, v60
  v_permlane32_swap_b32 v31, v61
  v_add_f32 v28, v28, v58
  v_add_f32 v29, v29, v59
  v_add_f32 v30, v30, v60
  v_add_f32 v31, v31, v61
  v_mov_b32 v58, v28
  v_mov_b32 v59, v29
  v_mov_b32 v60, v30
  v_mov_b32 v61, v31
  v_permlane16_swap_b32 v28, v58
  v_permlane16_swap_b32 v29, v59
  v_permlane16_swap_b32 v30, v60
  v_permlane16_swap_b32 v31, v61
  v_add_f32 v28, v28, v58
  v_add_f32 v29, v29, v59
  v_add_f32 v30, v30, v60
  v_add_f32 v31, v31, v61
  v_rcp_f32 v28, v28
  v_rcp_f32 v29, v29
  v_rcp_f32 v30, v30
  v_rcp_f32 v31, v31
  v_mov_b32 v48, v0
  v_xor_b32 v49, 32, v0
  v_xor_b32 v50, 64, v0
  v_xor_b32 v51, 96, v0
  v_xor_b32 v52, 128, v0
  v_xor_b32 v53, 160, v0
  v_xor_b32 v54, 192, v0
  v_xor_b32 v55, 224, v0
  v_mbcnt_lo_u32_b32 v57, -1, 0
  v_mbcnt_hi_u32_b32 v57, -1, v57
  v_lshl_add_u32 v57, v57, 4, s82
  v_accvgpr_read_b32 v192, a0
  v_accvgpr_read_b32 v193, a1
  v_accvgpr_read_b32 v194, a2
  v_accvgpr_read_b32 v195, a3
  v_pk_mul_f32 v[192:193], v[192:193], v[28:29] op_sel:[0,0] op_sel_hi:[1,0]
  v_pk_mul_f32 v[194:195], v[194:195], v[28:29] op_sel:[0,0] op_sel_hi:[1,0]
  v_cvt_pk_bf16_f32 v192, v192, v193
  v_cvt_pk_bf16_f32 v193, v194, v195
  ds_write_b64 v48, v[192:193] offset:0
  v_accvgpr_read_b32 v196, a4
  v_accvgpr_read_b32 v197, a5
  v_accvgpr_read_b32 v198, a6
  v_accvgpr_read_b32 v199, a7
  v_pk_mul_f32 v[196:197], v[196:197], v[28:29] op_sel:[0,0] op_sel_hi:[1,0]
  v_pk_mul_f32 v[198:199], v[198:199], v[28:29] op_sel:[0,0] op_sel_hi:[1,0]
  v_cvt_pk_bf16_f32 v196, v196, v197
  v_cvt_pk_bf16_f32 v197, v198, v199
  ds_write_b64 v49, v[196:197] offset:0
  v_accvgpr_read_b32 v200, a8
  v_accvgpr_read_b32 v201, a9
  v_accvgpr_read_b32 v202, a10
  v_accvgpr_read_b32 v203, a11
  v_pk_mul_f32 v[200:201], v[200:201], v[28:29] op_sel:[0,0] op_sel_hi:[1,0]
  v_pk_mul_f32 v[202:203], v[202:203], v[28:29] op_sel:[0,0] op_sel_hi:[1,0]
  v_cvt_pk_bf16_f32 v200, v200, v201
  v_cvt_pk_bf16_f32 v201, v202, v203
  ds_write_b64 v50, v[200:201] offset:0
  v_accvgpr_read_b32 v204, a12
  v_accvgpr_read_b32 v205, a13
  v_accvgpr_read_b32 v206, a14
  v_accvgpr_read_b32 v207, a15
  v_pk_mul_f32 v[204:205], v[204:205], v[28:29] op_sel:[0,0] op_sel_hi:[1,0]
  v_pk_mul_f32 v[206:207], v[206:207], v[28:29] op_sel:[0,0] op_sel_hi:[1,0]
  v_cvt_pk_bf16_f32 v204, v204, v205
  v_cvt_pk_bf16_f32 v205, v206, v207
  ds_write_b64 v51, v[204:205] offset:0
  v_accvgpr_read_b32 v192, a16
  v_accvgpr_read_b32 v193, a17
  v_accvgpr_read_b32 v194, a18
  v_accvgpr_read_b32 v195, a19
  v_pk_mul_f32 v[192:193], v[192:193], v[28:29] op_sel:[0,0] op_sel_hi:[1,0]
  v_pk_mul_f32 v[194:195], v[194:195], v[28:29] op_sel:[0,0] op_sel_hi:[1,0]
  v_cvt_pk_bf16_f32 v192, v192, v193
  v_cvt_pk_bf16_f32 v193, v194, v195
  ds_write_b64 v52, v[192:193] offset:0
  v_accvgpr_read_b32 v196, a20
  v_accvgpr_read_b32 v197, a21
  v_accvgpr_read_b32 v198, a22
  v_accvgpr_read_b32 v199, a23
  v_pk_mul_f32 v[196:197], v[196:197], v[28:29] op_sel:[0,0] op_sel_hi:[1,0]
  v_pk_mul_f32 v[198:199], v[198:199], v[28:29] op_sel:[0,0] op_sel_hi:[1,0]
  v_cvt_pk_bf16_f32 v196, v196, v197
  v_cvt_pk_bf16_f32 v197, v198, v199
  ds_write_b64 v53, v[196:197] offset:0
  v_accvgpr_read_b32 v200, a24
  v_accvgpr_read_b32 v201, a25
  v_accvgpr_read_b32 v202, a26
  v_accvgpr_read_b32 v203, a27
  v_pk_mul_f32 v[200:201], v[200:201], v[28:29] op_sel:[0,0] op_sel_hi:[1,0]
  v_pk_mul_f32 v[202:203], v[202:203], v[28:29] op_sel:[0,0] op_sel_hi:[1,0]
  v_cvt_pk_bf16_f32 v200, v200, v201
  v_cvt_pk_bf16_f32 v201, v202, v203
  ds_write_b64 v54, v[200:201] offset:0
  v_accvgpr_read_b32 v204, a28
  v_accvgpr_read_b32 v205, a29
  v_accvgpr_read_b32 v206, a30
  v_accvgpr_read_b32 v207, a31
  v_pk_mul_f32 v[204:205], v[204:205], v[28:29] op_sel:[0,0] op_sel_hi:[1,0]
  v_pk_mul_f32 v[206:207], v[206:207], v[28:29] op_sel:[0,0] op_sel_hi:[1,0]
  v_cvt_pk_bf16_f32 v204, v204, v205
  v_cvt_pk_bf16_f32 v205, v206, v207
  ds_write_b64 v55, v[204:205] offset:0
  ds_read_b128 v[208:211], v57 offset:0
  ds_read_b128 v[212:215], v57 offset:1024
  ds_read_b128 v[216:219], v57 offset:2048
  ds_read_b128 v[220:223], v57 offset:3072
  s_waitcnt lgkmcnt(3)
  buffer_store_dwordx4 v[208:211], v16, s[24:27], s3 offen sc1
  s_waitcnt lgkmcnt(2)
  buffer_store_dwordx4 v[212:215], v17, s[24:27], s3 offen offset:1024 sc1
  s_waitcnt lgkmcnt(1)
  buffer_store_dwordx4 v[216:219], v18, s[24:27], s3 offen offset:2048 sc1
  s_waitcnt lgkmcnt(0)
  buffer_store_dwordx4 v[220:223], v19, s[24:27], s3 offen offset:3072 sc1
  v_accvgpr_read_b32 v224, a32
  v_accvgpr_read_b32 v225, a33
  v_accvgpr_read_b32 v226, a34
  v_accvgpr_read_b32 v227, a35
  v_pk_mul_f32 v[224:225], v[224:225], v[28:29] op_sel:[0,1] op_sel_hi:[1,1]
  v_pk_mul_f32 v[226:227], v[226:227], v[28:29] op_sel:[0,1] op_sel_hi:[1,1]
  v_cvt_pk_bf16_f32 v224, v224, v225
  v_cvt_pk_bf16_f32 v225, v226, v227
  ds_write_b64 v48, v[224:225] offset:4096
  v_accvgpr_read_b32 v228, a36
  v_accvgpr_read_b32 v229, a37
  v_accvgpr_read_b32 v230, a38
  v_accvgpr_read_b32 v231, a39
  v_pk_mul_f32 v[228:229], v[228:229], v[28:29] op_sel:[0,1] op_sel_hi:[1,1]
  v_pk_mul_f32 v[230:231], v[230:231], v[28:29] op_sel:[0,1] op_sel_hi:[1,1]
  v_cvt_pk_bf16_f32 v228, v228, v229
  v_cvt_pk_bf16_f32 v229, v230, v231
  ds_write_b64 v49, v[228:229] offset:4096
  v_accvgpr_read_b32 v232, a40
  v_accvgpr_read_b32 v233, a41
  v_accvgpr_read_b32 v234, a42
  v_accvgpr_read_b32 v235, a43
  v_pk_mul_f32 v[232:233], v[232:233], v[28:29] op_sel:[0,1] op_sel_hi:[1,1]
  v_pk_mul_f32 v[234:235], v[234:235], v[28:29] op_sel:[0,1] op_sel_hi:[1,1]
  v_cvt_pk_bf16_f32 v232, v232, v233
  v_cvt_pk_bf16_f32 v233, v234, v235
  ds_write_b64 v50, v[232:233] offset:4096
  v_accvgpr_read_b32 v236, a44
  v_accvgpr_read_b32 v237, a45
  v_accvgpr_read_b32 v238, a46
  v_accvgpr_read_b32 v239, a47
  v_pk_mul_f32 v[236:237], v[236:237], v[28:29] op_sel:[0,1] op_sel_hi:[1,1]
  v_pk_mul_f32 v[238:239], v[238:239], v[28:29] op_sel:[0,1] op_sel_hi:[1,1]
  v_cvt_pk_bf16_f32 v236, v236, v237
  v_cvt_pk_bf16_f32 v237, v238, v239
  ds_write_b64 v51, v[236:237] offset:4096
  v_accvgpr_read_b32 v224, a48
  v_accvgpr_read_b32 v225, a49
  v_accvgpr_read_b32 v226, a50
  v_accvgpr_read_b32 v227, a51
  v_pk_mul_f32 v[224:225], v[224:225], v[28:29] op_sel:[0,1] op_sel_hi:[1,1]
  v_pk_mul_f32 v[226:227], v[226:227], v[28:29] op_sel:[0,1] op_sel_hi:[1,1]
  v_cvt_pk_bf16_f32 v224, v224, v225
  v_cvt_pk_bf16_f32 v225, v226, v227
  ds_write_b64 v52, v[224:225] offset:4096
  v_accvgpr_read_b32 v228, a52
  v_accvgpr_read_b32 v229, a53
  v_accvgpr_read_b32 v230, a54
  v_accvgpr_read_b32 v231, a55
  v_pk_mul_f32 v[228:229], v[228:229], v[28:29] op_sel:[0,1] op_sel_hi:[1,1]
  v_pk_mul_f32 v[230:231], v[230:231], v[28:29] op_sel:[0,1] op_sel_hi:[1,1]
  v_cvt_pk_bf16_f32 v228, v228, v229
  v_cvt_pk_bf16_f32 v229, v230, v231
  ds_write_b64 v53, v[228:229] offset:4096
  v_accvgpr_read_b32 v232, a56
  v_accvgpr_read_b32 v233, a57
  v_accvgpr_read_b32 v234, a58
  v_accvgpr_read_b32 v235, a59
  v_pk_mul_f32 v[232:233], v[232:233], v[28:29] op_sel:[0,1] op_sel_hi:[1,1]
  v_pk_mul_f32 v[234:235], v[234:235], v[28:29] op_sel:[0,1] op_sel_hi:[1,1]
  v_cvt_pk_bf16_f32 v232, v232, v233
  v_cvt_pk_bf16_f32 v233, v234, v235
  ds_write_b64 v54, v[232:233] offset:4096
  v_accvgpr_read_b32 v236, a60
  v_accvgpr_read_b32 v237, a61
  v_accvgpr_read_b32 v238, a62
  v_accvgpr_read_b32 v239, a63
  v_pk_mul_f32 v[236:237], v[236:237], v[28:29] op_sel:[0,1] op_sel_hi:[1,1]
  v_pk_mul_f32 v[238:239], v[238:239], v[28:29] op_sel:[0,1] op_sel_hi:[1,1]
  v_cvt_pk_bf16_f32 v236, v236, v237
  v_cvt_pk_bf16_f32 v237, v238, v239
  ds_write_b64 v55, v[236:237] offset:4096
  ds_read_b128 v[240:243], v57 offset:4096
  ds_read_b128 v[244:247], v57 offset:5120
  ds_read_b128 v[248:251], v57 offset:6144
  ds_read_b128 v[252:255], v57 offset:7168
  s_waitcnt lgkmcnt(3)
  buffer_store_dwordx4 v[240:243], v16, s[24:27], s33 offen sc1
  s_waitcnt lgkmcnt(2)
  buffer_store_dwordx4 v[244:247], v17, s[24:27], s33 offen offset:1024 sc1
  s_waitcnt lgkmcnt(1)
  buffer_store_dwordx4 v[248:251], v18, s[24:27], s33 offen offset:2048 sc1
  s_waitcnt lgkmcnt(0)
  buffer_store_dwordx4 v[252:255], v19, s[24:27], s33 offen offset:3072 sc1
  v_accvgpr_read_b32 v192, a64
  v_accvgpr_read_b32 v193, a65
  v_accvgpr_read_b32 v194, a66
  v_accvgpr_read_b32 v195, a67
  v_pk_mul_f32 v[192:193], v[192:193], v[30:31] op_sel:[0,0] op_sel_hi:[1,0]
  v_pk_mul_f32 v[194:195], v[194:195], v[30:31] op_sel:[0,0] op_sel_hi:[1,0]
  v_cvt_pk_bf16_f32 v192, v192, v193
  v_cvt_pk_bf16_f32 v193, v194, v195
  ds_write_b64 v48, v[192:193] offset:8192
  v_accvgpr_read_b32 v196, a68
  v_accvgpr_read_b32 v197, a69
  v_accvgpr_read_b32 v198, a70
  v_accvgpr_read_b32 v199, a71
  v_pk_mul_f32 v[196:197], v[196:197], v[30:31] op_sel:[0,0] op_sel_hi:[1,0]
  v_pk_mul_f32 v[198:199], v[198:199], v[30:31] op_sel:[0,0] op_sel_hi:[1,0]
  v_cvt_pk_bf16_f32 v196, v196, v197
  v_cvt_pk_bf16_f32 v197, v198, v199
  ds_write_b64 v49, v[196:197] offset:8192
  v_accvgpr_read_b32 v200, a72
  v_accvgpr_read_b32 v201, a73
  v_accvgpr_read_b32 v202, a74
  v_accvgpr_read_b32 v203, a75
  v_pk_mul_f32 v[200:201], v[200:201], v[30:31] op_sel:[0,0] op_sel_hi:[1,0]
  v_pk_mul_f32 v[202:203], v[202:203], v[30:31] op_sel:[0,0] op_sel_hi:[1,0]
  v_cvt_pk_bf16_f32 v200, v200, v201
  v_cvt_pk_bf16_f32 v201, v202, v203
  ds_write_b64 v50, v[200:201] offset:8192
  v_accvgpr_read_b32 v204, a76
  v_accvgpr_read_b32 v205, a77
  v_accvgpr_read_b32 v206, a78
  v_accvgpr_read_b32 v207, a79
  v_pk_mul_f32 v[204:205], v[204:205], v[30:31] op_sel:[0,0] op_sel_hi:[1,0]
  v_pk_mul_f32 v[206:207], v[206:207], v[30:31] op_sel:[0,0] op_sel_hi:[1,0]
  v_cvt_pk_bf16_f32 v204, v204, v205
  v_cvt_pk_bf16_f32 v205, v206, v207
  ds_write_b64 v51, v[204:205] offset:8192
  v_accvgpr_read_b32 v192, a80
  v_accvgpr_read_b32 v193, a81
  v_accvgpr_read_b32 v194, a82
  v_accvgpr_read_b32 v195, a83
  v_pk_mul_f32 v[192:193], v[192:193], v[30:31] op_sel:[0,0] op_sel_hi:[1,0]
  v_pk_mul_f32 v[194:195], v[194:195], v[30:31] op_sel:[0,0] op_sel_hi:[1,0]
  v_cvt_pk_bf16_f32 v192, v192, v193
  v_cvt_pk_bf16_f32 v193, v194, v195
  ds_write_b64 v52, v[192:193] offset:8192
  v_accvgpr_read_b32 v196, a84
  v_accvgpr_read_b32 v197, a85
  v_accvgpr_read_b32 v198, a86
  v_accvgpr_read_b32 v199, a87
  v_pk_mul_f32 v[196:197], v[196:197], v[30:31] op_sel:[0,0] op_sel_hi:[1,0]
  v_pk_mul_f32 v[198:199], v[198:199], v[30:31] op_sel:[0,0] op_sel_hi:[1,0]
  v_cvt_pk_bf16_f32 v196, v196, v197
  v_cvt_pk_bf16_f32 v197, v198, v199
  ds_write_b64 v53, v[196:197] offset:8192
  v_accvgpr_read_b32 v200, a88
  v_accvgpr_read_b32 v201, a89
  v_accvgpr_read_b32 v202, a90
  v_accvgpr_read_b32 v203, a91
  v_pk_mul_f32 v[200:201], v[200:201], v[30:31] op_sel:[0,0] op_sel_hi:[1,0]
  v_pk_mul_f32 v[202:203], v[202:203], v[30:31] op_sel:[0,0] op_sel_hi:[1,0]
  v_cvt_pk_bf16_f32 v200, v200, v201
  v_cvt_pk_bf16_f32 v201, v202, v203
  ds_write_b64 v54, v[200:201] offset:8192
  v_accvgpr_read_b32 v204, a92
  v_accvgpr_read_b32 v205, a93
  v_accvgpr_read_b32 v206, a94
  v_accvgpr_read_b32 v207, a95
  v_pk_mul_f32 v[204:205], v[204:205], v[30:31] op_sel:[0,0] op_sel_hi:[1,0]
  v_pk_mul_f32 v[206:207], v[206:207], v[30:31] op_sel:[0,0] op_sel_hi:[1,0]
  v_cvt_pk_bf16_f32 v204, v204, v205
  v_cvt_pk_bf16_f32 v205, v206, v207
  ds_write_b64 v55, v[204:205] offset:8192
  ds_read_b128 v[208:211], v57 offset:8192
  ds_read_b128 v[212:215], v57 offset:9216
  ds_read_b128 v[216:219], v57 offset:10240
  ds_read_b128 v[220:223], v57 offset:11264
  s_waitcnt lgkmcnt(3)
  buffer_store_dwordx4 v[208:211], v16, s[24:27], s34 offen sc1
  s_waitcnt lgkmcnt(2)
  buffer_store_dwordx4 v[212:215], v17, s[24:27], s34 offen offset:1024 sc1
  s_waitcnt lgkmcnt(1)
  buffer_store_dwordx4 v[216:219], v18, s[24:27], s34 offen offset:2048 sc1
  s_waitcnt lgkmcnt(0)
  buffer_store_dwordx4 v[220:223], v19, s[24:27], s34 offen offset:3072 sc1
  v_accvgpr_read_b32 v224, a96
  v_accvgpr_read_b32 v225, a97
  v_accvgpr_read_b32 v226, a98
  v_accvgpr_read_b32 v227, a99
  v_pk_mul_f32 v[224:225], v[224:225], v[30:31] op_sel:[0,1] op_sel_hi:[1,1]
  v_pk_mul_f32 v[226:227], v[226:227], v[30:31] op_sel:[0,1] op_sel_hi:[1,1]
  v_cvt_pk_bf16_f32 v224, v224, v225
  v_cvt_pk_bf16_f32 v225, v226, v227
  ds_write_b64 v48, v[224:225] offset:12288
  v_accvgpr_read_b32 v228, a100
  v_accvgpr_read_b32 v229, a101
  v_accvgpr_read_b32 v230, a102
  v_accvgpr_read_b32 v231, a103
  v_pk_mul_f32 v[228:229], v[228:229], v[30:31] op_sel:[0,1] op_sel_hi:[1,1]
  v_pk_mul_f32 v[230:231], v[230:231], v[30:31] op_sel:[0,1] op_sel_hi:[1,1]
  v_cvt_pk_bf16_f32 v228, v228, v229
  v_cvt_pk_bf16_f32 v229, v230, v231
  ds_write_b64 v49, v[228:229] offset:12288
  v_accvgpr_read_b32 v232, a104
  v_accvgpr_read_b32 v233, a105
  v_accvgpr_read_b32 v234, a106
  v_accvgpr_read_b32 v235, a107
  v_pk_mul_f32 v[232:233], v[232:233], v[30:31] op_sel:[0,1] op_sel_hi:[1,1]
  v_pk_mul_f32 v[234:235], v[234:235], v[30:31] op_sel:[0,1] op_sel_hi:[1,1]
  v_cvt_pk_bf16_f32 v232, v232, v233
  v_cvt_pk_bf16_f32 v233, v234, v235
  ds_write_b64 v50, v[232:233] offset:12288
  v_accvgpr_read_b32 v236, a108
  v_accvgpr_read_b32 v237, a109
  v_accvgpr_read_b32 v238, a110
  v_accvgpr_read_b32 v239, a111
  v_pk_mul_f32 v[236:237], v[236:237], v[30:31] op_sel:[0,1] op_sel_hi:[1,1]
  v_pk_mul_f32 v[238:239], v[238:239], v[30:31] op_sel:[0,1] op_sel_hi:[1,1]
  v_cvt_pk_bf16_f32 v236, v236, v237
  v_cvt_pk_bf16_f32 v237, v238, v239
  ds_write_b64 v51, v[236:237] offset:12288
  v_accvgpr_read_b32 v224, a112
  v_accvgpr_read_b32 v225, a113
  v_accvgpr_read_b32 v226, a114
  v_accvgpr_read_b32 v227, a115
  v_pk_mul_f32 v[224:225], v[224:225], v[30:31] op_sel:[0,1] op_sel_hi:[1,1]
  v_pk_mul_f32 v[226:227], v[226:227], v[30:31] op_sel:[0,1] op_sel_hi:[1,1]
  v_cvt_pk_bf16_f32 v224, v224, v225
  v_cvt_pk_bf16_f32 v225, v226, v227
  ds_write_b64 v52, v[224:225] offset:12288
  v_accvgpr_read_b32 v228, a116
  v_accvgpr_read_b32 v229, a117
  v_accvgpr_read_b32 v230, a118
  v_accvgpr_read_b32 v231, a119
  v_pk_mul_f32 v[228:229], v[228:229], v[30:31] op_sel:[0,1] op_sel_hi:[1,1]
  v_pk_mul_f32 v[230:231], v[230:231], v[30:31] op_sel:[0,1] op_sel_hi:[1,1]
  v_cvt_pk_bf16_f32 v228, v228, v229
  v_cvt_pk_bf16_f32 v229, v230, v231
  ds_write_b64 v53, v[228:229] offset:12288
  v_accvgpr_read_b32 v232, a120
  v_accvgpr_read_b32 v233, a121
  v_accvgpr_read_b32 v234, a122
  v_accvgpr_read_b32 v235, a123
  v_pk_mul_f32 v[232:233], v[232:233], v[30:31] op_sel:[0,1] op_sel_hi:[1,1]
  v_pk_mul_f32 v[234:235], v[234:235], v[30:31] op_sel:[0,1] op_sel_hi:[1,1]
  v_cvt_pk_bf16_f32 v232, v232, v233
  v_cvt_pk_bf16_f32 v233, v234, v235
  ds_write_b64 v54, v[232:233] offset:12288
  v_accvgpr_read_b32 v236, a124
  v_accvgpr_read_b32 v237, a125
  v_accvgpr_read_b32 v238, a126
  v_accvgpr_read_b32 v239, a127
  v_pk_mul_f32 v[236:237], v[236:237], v[30:31] op_sel:[0,1] op_sel_hi:[1,1]
  v_pk_mul_f32 v[238:239], v[238:239], v[30:31] op_sel:[0,1] op_sel_hi:[1,1]
  v_cvt_pk_bf16_f32 v236, v236, v237
  v_cvt_pk_bf16_f32 v237, v238, v239
  ds_write_b64 v55, v[236:237] offset:12288
  ds_read_b128 v[240:243], v57 offset:12288
  ds_read_b128 v[244:247], v57 offset:13312
  ds_read_b128 v[248:251], v57 offset:14336
  ds_read_b128 v[252:255], v57 offset:15360
  s_waitcnt lgkmcnt(3)
  buffer_store_dwordx4 v[240:243], v16, s[24:27], s35 offen sc1
  s_waitcnt lgkmcnt(2)
  buffer_store_dwordx4 v[244:247], v17, s[24:27], s35 offen offset:1024 sc1
  s_waitcnt lgkmcnt(1)
  buffer_store_dwordx4 v[248:251], v18, s[24:27], s35 offen offset:2048 sc1
  s_waitcnt lgkmcnt(0)
  buffer_store_dwordx4 v[252:255], v19, s[24:27], s35 offen offset:3072 sc1
  s_endpgm
.section .rodata,"a"
.p2align 6
.amdhsa_kernel standalone__softmax_full_bidir__prompt_kernel
  .amdhsa_next_free_vgpr 512
  .amdhsa_next_free_sgpr 96
  .amdhsa_accum_offset 256
  .amdhsa_group_segment_fixed_size 0
  .amdhsa_kernarg_size 48
  .amdhsa_user_sgpr_count 2
  .amdhsa_user_sgpr_kernarg_segment_ptr 1
  .amdhsa_system_sgpr_workgroup_id_x 1
.end_amdhsa_kernel
```
